```python
import torch

def _softmax(x, axis=-1):
    return torch.softmax(x, dim=axis)
def _gelu(x):
    return torch.nn.functional.gelu(x, approximate="tanh")
def _silu(x):
    return torch.nn.functional.silu(x)
def _sigmoid(x):
    return torch.sigmoid(x)
def _layernorm(x, axis=-1, eps=1e-5):
    m = x.mean(dim=axis, keepdim=True)
    v = x.var(dim=axis, keepdim=True, unbiased=False)
    return (x - m) / torch.sqrt(v + eps)
def _scatter_add(tgt, idx, src, axis=0):
    return tgt.clone().index_add_(axis, idx, src)
def _segment_sum(src, seg, n):
    out = torch.zeros((n,) + src.shape[1:], dtype=src.dtype)
    return out.index_add_(0, seg, src)
def _pad(x, pw):
    flat = tuple(v for pair in reversed(pw) for v in pair)
    return torch.nn.functional.pad(x, flat)

kernel_name = 'standalone__kv_cache_quant_int4_int2_kv_with_per_channel_or_per_token_scales__decode'

def setup_inputs():

    _w = (lambda a: (lambda t: t.to(torch.bfloat16) if t.is_floating_point() else t)(torch.as_tensor(a)))
    B = 4
    Sq = 1
    Skv = 4096
    Hq = 32
    Hkv = 8
    Dh = 128
    bits = 8
    G = -1
    if G <= 0 or G >= Skv:
        G = max(1, Skv // 2)
    Skv = (Skv // G) * G
    ngk = Skv // G
    qmax = (1 << bits) - 1
    return {
        "q": _w((lambda *s: torch.randn(*s, dtype=torch.bfloat16) * 0.2)(B, Hq, Sq, Dh)),
        "qk": _w(torch.randint(0, qmax + 1, (B, Hkv, Skv, Dh)).to(torch.int32)),
        "qv": _w(torch.randint(0, qmax + 1, (B, Hkv, Skv, Dh)).to(torch.int32)),
        "k_scales": _w(torch.abs((lambda *s: torch.randn(*s, dtype=torch.bfloat16) * 0.2)(B, Hkv, ngk, Dh)) * 0.05 + 0.02),
        "k_zeros": _w((lambda *s: torch.randn(*s, dtype=torch.bfloat16) * 0.2)(B, Hkv, ngk, Dh) + float(qmax) / 2.0),
        "v_scales": _w(torch.abs((lambda *s: torch.randn(*s, dtype=torch.bfloat16) * 0.05)(B, Hkv, Skv, 1)) * 0.05 + 0.02),
        "v_zeros": _w((lambda *s: torch.randn(*s, dtype=torch.bfloat16) * 0.05)(B, Hkv, Skv, 1) + float(qmax) / 2.0),
    }

def reference(q, qk, qv, k_scales, k_zeros, v_scales, v_zeros):
    B, Hq, Sq, Dh = q.shape
    Hkv, Skv = qk.shape[1], qk.shape[2]
    ngk = k_scales.shape[2]
    G = Skv // ngk
    ks = (lambda x, n, axis: torch.repeat_interleave(x, n, dim=axis))(k_scales, G, axis=2)
    kz = (lambda x, n, axis: torch.repeat_interleave(x, n, dim=axis))(k_zeros, G, axis=2)
    k = ((lambda x, dt: x.to(dt))(qk, q.dtype) - kz) * ks
    v = ((lambda x, dt: x.to(dt))(qv, q.dtype) - v_zeros) * v_scales
    rep = Hq // Hkv
    if rep > 1:
        k = (lambda x, n, axis: torch.repeat_interleave(x, n, dim=axis))(k, rep, axis=1)
        v = (lambda x, n, axis: torch.repeat_interleave(x, n, dim=axis))(v, rep, axis=1)
    scale = float(Dh) ** -0.5
    logits = torch.einsum("bhqd,bhkd->bhqk", q, k) * scale
    p = _softmax(logits, axis=-1)
    o = torch.einsum("bhqk,bhkd->bhqd", p, v)
    return o
```

```asm
; @launch grid=(256,1,1) block=(256,1,1) lds=16640
.amdgcn_target "amdgcn-amd-amdhsa--gfx950"
.text
.globl standalone__kv_cache_quant_int4_int2_kv_with_per_channel_or_per_token_scales__decode_kernel
.p2align 8
.type standalone__kv_cache_quant_int4_int2_kv_with_per_channel_or_per_token_scales__decode_kernel,@function
standalone__kv_cache_quant_int4_int2_kv_with_per_channel_or_per_token_scales__decode_kernel:
    s_cmp_ge_u32 s2, 256
    s_cbranch_scc1 L_end
    s_load_dwordx16 s[4:19], s[0:1], 0
    s_load_dwordx2 s[22:23], s[0:1], 72
    v_lshrrev_b32 v3, 6, v0
    v_and_b32 v0, 63, v0
    v_readfirstlane_b32 s3, v3
    v_and_b32 v3, 3, v0
    v_lshrrev_b32 v4, 4, v0
    v_bfe_u32 v5, v0, 2, 2
    v_lshlrev_b32 v1, 4, v3
    v_lshl_or_b32 v1, v4, 6, v1
    v_lshl_or_b32 v1, v5, 9, v1
    v_lshlrev_b32 v2, 4, v0
    s_and_b32 s40, s2, 31
    s_lshr_b32 s41, s2, 5
    s_lshl_b32 s53, s40, 3
    s_add_u32 s53, s53, s41
    s_lshl_b32 s42, s53, 18
    s_lshl_b32 s43, s3, 11
    s_add_u32 s32, s42, s43
    v_lshlrev_b32 v8, 5, v4
    v_lshl_or_b32 v9, v3, 3, v8
    v_lshl_or_b32 v8, v5, 3, v8
    v_lshl_or_b32 v7, v3, 8, v8
    v_lshl_or_b32 v11, v5, 2, v3
    v_lshlrev_b32 v11, 5, v11
    v_lshl_or_b32 v11, v4, 1, v11
    s_lshl_b32 s43, s3, 3
    v_add_u32 v11, s43, v11
    s_waitcnt lgkmcnt(0)
    s_mov_b32 s24, s6
    s_and_b32 s25, s7, 0xffff
    s_mov_b32 s26, 0x4000000
    s_mov_b32 s27, 0x20000
    s_mov_b32 s28, s8
    s_and_b32 s29, s9, 0xffff
    s_mov_b32 s30, 0x4000000
    s_mov_b32 s31, 0x20000
    s_add_u32 s33, s32, 0
    buffer_load_dwordx4 v[84:87], v1, s[24:27], s33 offen offset:0 nt
    buffer_load_dwordx4 v[88:91], v1, s[24:27], s33 offen offset:256 nt
    s_add_u32 s33, s32, 8192
    buffer_load_dwordx4 v[92:95], v1, s[24:27], s33 offen offset:0 nt
    buffer_load_dwordx4 v[96:99], v1, s[24:27], s33 offen offset:256 nt
    s_add_u32 s33, s32, 16384
    buffer_load_dwordx4 v[100:103], v1, s[24:27], s33 offen offset:0 nt
    buffer_load_dwordx4 v[104:107], v1, s[24:27], s33 offen offset:256 nt
    s_getpc_b64 s[56:57]
L_pc:
    s_lshr_b32 s58, s2, 3
    s_lshl_b32 s58, s58, 2
    s_add_u32 s58, s58, s3
    s_lshl_b32 s58, s58, 7
    s_min_u32 s58, s58, 12084
    s_add_u32 s56, s56, s58
    s_addc_u32 s57, s57, 0
    s_load_dword s58, s[56:57], 0
    s_lshl_b32 s42, s40, 10
    s_add_u32 s4, s4, s42
    s_addc_u32 s5, s5, 0
    s_lshr_b32 s42, s53, 2
    s_lshl_b32 s42, s42, 8
    s_add_u32 s10, s10, s42
    s_addc_u32 s11, s11, 0
    s_add_u32 s12, s12, s42
    s_addc_u32 s13, s13, 0
    global_load_dwordx2 v[40:41], v7, s[4:5]
    global_load_dwordx2 v[42:43], v7, s[4:5] offset:128
    global_load_dwordx2 v[44:45], v8, s[10:11]
    global_load_dwordx2 v[46:47], v8, s[10:11] offset:128
    global_load_dwordx2 v[48:49], v9, s[12:13]
    global_load_dwordx2 v[50:51], v9, s[12:13] offset:128
    s_lshl_b32 s42, s53, 10
    s_add_u32 s14, s14, s42
    s_addc_u32 s15, s15, 0
    s_add_u32 s16, s16, s42
    s_addc_u32 s17, s17, 0
    s_lshl_b32 s42, s53, 12
    s_add_u32 s44, s22, s42
    s_addc_u32 s45, s23, 0
    s_lshl_b32 s42, s40, 15
    s_add_u32 s46, s22, s42
    s_addc_u32 s47, s23, 0
    s_lshl_b32 s42, s40, 7
    s_add_u32 s42, s42, 0x100000
    s_add_u32 s48, s22, s42
    s_addc_u32 s49, s23, 0
    v_mov_b32 v81, 0
    s_cmp_eq_u32 s41, 7
    s_cselect_b32 s54, s3, 1
    s_cmp_lg_u32 s54, 0
    s_cbranch_scc1 L_noearly
    global_load_dword v80, v81, s[48:49] sc1
L_noearly:
    v_lshrrev_b32 v21, 5, v0
    v_lshlrev_b32 v21, 5, v21
    v_lshl_or_b32 v21, v3, 3, v21
    s_lshl_b32 s43, s3, 11
    v_add_u32 v21, s43, v21
    s_waitcnt vmcnt(10)
    v_cvt_f32_i32 v84, v84
    v_cvt_f32_i32 v85, v85
    v_cvt_f32_i32 v86, v86
    v_cvt_f32_i32 v87, v87
    v_cvt_f32_i32 v88, v88
    v_cvt_f32_i32 v89, v89
    v_cvt_f32_i32 v90, v90
    v_cvt_f32_i32 v91, v91
    v_cvt_pk_bf16_f32 v132, v84, v85
    v_cvt_pk_bf16_f32 v133, v86, v87
    v_cvt_pk_bf16_f32 v134, v88, v89
    v_cvt_pk_bf16_f32 v135, v90, v91
    s_add_u32 s33, s32, 24576
    buffer_load_dwordx4 v[108:111], v1, s[24:27], s33 offen offset:0 nt
    buffer_load_dwordx4 v[112:115], v1, s[24:27], s33 offen offset:256 nt
    s_waitcnt vmcnt(10)
    v_cvt_f32_i32 v92, v92
    v_cvt_f32_i32 v93, v93
    v_cvt_f32_i32 v94, v94
    v_cvt_f32_i32 v95, v95
    v_cvt_f32_i32 v96, v96
    v_cvt_f32_i32 v97, v97
    v_cvt_f32_i32 v98, v98
    v_cvt_f32_i32 v99, v99
    v_cvt_pk_bf16_f32 v136, v92, v93
    v_cvt_pk_bf16_f32 v137, v94, v95
    v_cvt_pk_bf16_f32 v138, v96, v97
    v_cvt_pk_bf16_f32 v139, v98, v99
    s_add_u32 s33, s32, 32768
    buffer_load_dwordx4 v[116:119], v1, s[24:27], s33 offen offset:0 nt
    buffer_load_dwordx4 v[120:123], v1, s[24:27], s33 offen offset:256 nt
    s_waitcnt vmcnt(10)
    v_cvt_f32_i32 v100, v100
    v_cvt_f32_i32 v101, v101
    v_cvt_f32_i32 v102, v102
    v_cvt_f32_i32 v103, v103
    v_cvt_f32_i32 v104, v104
    v_cvt_f32_i32 v105, v105
    v_cvt_f32_i32 v106, v106
    v_cvt_f32_i32 v107, v107
    v_cvt_pk_bf16_f32 v140, v100, v101
    v_cvt_pk_bf16_f32 v141, v102, v103
    v_cvt_pk_bf16_f32 v142, v104, v105
    v_cvt_pk_bf16_f32 v143, v106, v107
    s_add_u32 s33, s32, 40960
    buffer_load_dwordx4 v[124:127], v1, s[24:27], s33 offen offset:0 nt
    buffer_load_dwordx4 v[128:131], v1, s[24:27], s33 offen offset:256 nt
    s_waitcnt vmcnt(6)
    s_mov_b32 s42, 0x3e0293ee
    s_mov_b32 s43, 0xffff0000
    v_lshlrev_b32 v3, 16, v40
    v_and_b32 v4, s43, v40
    v_lshlrev_b32 v5, 16, v44
    v_and_b32 v6, s43, v44
    v_mul_f32 v3, v3, v5
    v_mul_f32 v4, v4, v6
    v_mul_f32 v3, s42, v3
    v_mul_f32 v4, s42, v4
    v_cvt_pk_bf16_f32 v12, v3, v4
    v_lshlrev_b32 v5, 16, v12
    v_and_b32 v6, s43, v12
    v_sub_f32 v3, v3, v5
    v_sub_f32 v4, v4, v6
    v_cvt_pk_bf16_f32 v16, v3, v4
    v_lshlrev_b32 v3, 16, v41
    v_and_b32 v4, s43, v41
    v_lshlrev_b32 v5, 16, v45
    v_and_b32 v6, s43, v45
    v_mul_f32 v3, v3, v5
    v_mul_f32 v4, v4, v6
    v_mul_f32 v3, s42, v3
    v_mul_f32 v4, s42, v4
    v_cvt_pk_bf16_f32 v13, v3, v4
    v_lshlrev_b32 v5, 16, v13
    v_and_b32 v6, s43, v13
    v_sub_f32 v3, v3, v5
    v_sub_f32 v4, v4, v6
    v_cvt_pk_bf16_f32 v17, v3, v4
    v_lshlrev_b32 v3, 16, v42
    v_and_b32 v4, s43, v42
    v_lshlrev_b32 v5, 16, v46
    v_and_b32 v6, s43, v46
    v_mul_f32 v3, v3, v5
    v_mul_f32 v4, v4, v6
    v_mul_f32 v3, s42, v3
    v_mul_f32 v4, s42, v4
    v_cvt_pk_bf16_f32 v14, v3, v4
    v_lshlrev_b32 v5, 16, v14
    v_and_b32 v6, s43, v14
    v_sub_f32 v3, v3, v5
    v_sub_f32 v4, v4, v6
    v_cvt_pk_bf16_f32 v18, v3, v4
    v_lshlrev_b32 v3, 16, v43
    v_and_b32 v4, s43, v43
    v_lshlrev_b32 v5, 16, v47
    v_and_b32 v6, s43, v47
    v_mul_f32 v3, v3, v5
    v_mul_f32 v4, v4, v6
    v_mul_f32 v3, s42, v3
    v_mul_f32 v4, s42, v4
    v_cvt_pk_bf16_f32 v15, v3, v4
    v_lshlrev_b32 v5, 16, v15
    v_and_b32 v6, s43, v15
    v_sub_f32 v3, v3, v5
    v_sub_f32 v4, v4, v6
    v_cvt_pk_bf16_f32 v19, v3, v4
    s_nop 1
    v_mfma_f32_16x16x32_bf16 v[56:59], v[48:51], v[12:15], 0
    v_mfma_f32_16x16x32_bf16 v[56:59], v[48:51], v[16:19], v[56:59]
    s_nop 7
    v_mov_b32_dpp v20, v56 quad_perm:[0,1,2,3] row_mask:0xf bank_mask:0x1
    v_mov_b32_dpp v20, v57 quad_perm:[0,1,2,3] row_mask:0xf bank_mask:0x2
    v_mov_b32_dpp v20, v58 quad_perm:[0,1,2,3] row_mask:0xf bank_mask:0x4
    v_mov_b32_dpp v20, v59 quad_perm:[0,1,2,3] row_mask:0xf bank_mask:0x8
    s_nop 1
    v_add_f32_dpp v20, v20, v20 row_ror:4 row_mask:0xf bank_mask:0xf
    s_nop 1
    v_add_f32_dpp v20, v20, v20 row_ror:8 row_mask:0xf bank_mask:0xf
    v_sub_f32 v20, 0, v20
    v_mfma_f32_16x16x32_bf16 v[56:59], v[132:135], v[12:15], 0
    v_mfma_f32_16x16x32_bf16 v[56:59], v[132:135], v[16:19], v[56:59]
    v_mfma_f32_16x16x32_bf16 v[60:63], v[136:139], v[12:15], 0
    v_mfma_f32_16x16x32_bf16 v[60:63], v[136:139], v[16:19], v[60:63]
    v_mfma_f32_16x16x32_bf16 v[64:67], v[140:143], v[12:15], 0
    v_mfma_f32_16x16x32_bf16 v[64:67], v[140:143], v[16:19], v[64:67]
    s_nop 7
    v_add_f32_dpp v28, v56, v20 quad_perm:[0,1,2,3] row_mask:0xf bank_mask:0x1
    v_add_f32_dpp v28, v57, v28 row_ror:12 row_mask:0xf bank_mask:0x1
    v_add_f32_dpp v28, v58, v28 row_ror:8 row_mask:0xf bank_mask:0x1
    v_add_f32_dpp v28, v59, v28 row_ror:4 row_mask:0xf bank_mask:0x1
    v_add_f32_dpp v29, v60, v20 quad_perm:[0,1,2,3] row_mask:0xf bank_mask:0x1
    v_add_f32_dpp v29, v61, v29 row_ror:12 row_mask:0xf bank_mask:0x1
    v_add_f32_dpp v29, v62, v29 row_ror:8 row_mask:0xf bank_mask:0x1
    v_add_f32_dpp v29, v63, v29 row_ror:4 row_mask:0xf bank_mask:0x1
    s_waitcnt vmcnt(5)
    v_cvt_f32_i32 v108, v108
    v_cvt_f32_i32 v109, v109
    v_cvt_f32_i32 v110, v110
    v_cvt_f32_i32 v111, v111
    v_cvt_pk_bf16_f32 v44, v108, v109
    v_cvt_pk_bf16_f32 v45, v110, v111
    s_add_u32 s33, s32, 49152
    buffer_load_dwordx4 v[84:87], v1, s[24:27], s33 offen offset:0 nt
    s_waitcnt vmcnt(5)
    v_cvt_f32_i32 v112, v112
    v_cvt_f32_i32 v113, v113
    v_cvt_f32_i32 v114, v114
    v_cvt_f32_i32 v115, v115
    v_cvt_pk_bf16_f32 v46, v112, v113
    v_cvt_pk_bf16_f32 v47, v114, v115
    buffer_load_dwordx4 v[88:91], v1, s[24:27], s33 offen offset:256 nt
    s_nop 0
    v_mfma_f32_16x16x32_bf16 v[68:71], v[44:47], v[12:15], 0
    v_mfma_f32_16x16x32_bf16 v[68:71], v[44:47], v[16:19], v[68:71]
    v_add_f32_dpp v30, v64, v20 quad_perm:[0,1,2,3] row_mask:0xf bank_mask:0x1
    v_add_f32_dpp v30, v65, v30 row_ror:12 row_mask:0xf bank_mask:0x1
    v_add_f32_dpp v30, v66, v30 row_ror:8 row_mask:0xf bank_mask:0x1
    v_add_f32_dpp v30, v67, v30 row_ror:4 row_mask:0xf bank_mask:0x1
    s_waitcnt vmcnt(5)
    v_cvt_f32_i32 v116, v116
    v_cvt_f32_i32 v117, v117
    v_cvt_f32_i32 v118, v118
    v_cvt_f32_i32 v119, v119
    v_cvt_pk_bf16_f32 v40, v116, v117
    v_cvt_pk_bf16_f32 v41, v118, v119
    s_add_u32 s33, s32, 57344
    buffer_load_dwordx4 v[92:95], v1, s[24:27], s33 offen offset:0 nt
    s_waitcnt vmcnt(5)
    v_cvt_f32_i32 v120, v120
    v_cvt_f32_i32 v121, v121
    v_cvt_f32_i32 v122, v122
    v_cvt_f32_i32 v123, v123
    v_cvt_pk_bf16_f32 v42, v120, v121
    v_cvt_pk_bf16_f32 v43, v122, v123
    buffer_load_dwordx4 v[96:99], v1, s[24:27], s33 offen offset:256 nt
    s_nop 0
    v_mfma_f32_16x16x32_bf16 v[56:59], v[40:43], v[12:15], 0
    v_mfma_f32_16x16x32_bf16 v[56:59], v[40:43], v[16:19], v[56:59]
    v_add_f32_dpp v31, v68, v20 quad_perm:[0,1,2,3] row_mask:0xf bank_mask:0x1
    v_add_f32_dpp v31, v69, v31 row_ror:12 row_mask:0xf bank_mask:0x1
    v_add_f32_dpp v31, v70, v31 row_ror:8 row_mask:0xf bank_mask:0x1
    v_add_f32_dpp v31, v71, v31 row_ror:4 row_mask:0xf bank_mask:0x1
    s_waitcnt vmcnt(5)
    v_cvt_f32_i32 v124, v124
    v_cvt_f32_i32 v125, v125
    v_cvt_f32_i32 v126, v126
    v_cvt_f32_i32 v127, v127
    v_cvt_pk_bf16_f32 v44, v124, v125
    v_cvt_pk_bf16_f32 v45, v126, v127
    s_add_u32 s33, s32, 65536
    buffer_load_dwordx4 v[100:103], v1, s[24:27], s33 offen offset:0 nt
    s_waitcnt vmcnt(5)
    v_cvt_f32_i32 v128, v128
    v_cvt_f32_i32 v129, v129
    v_cvt_f32_i32 v130, v130
    v_cvt_f32_i32 v131, v131
    v_cvt_pk_bf16_f32 v46, v128, v129
    v_cvt_pk_bf16_f32 v47, v130, v131
    buffer_load_dwordx4 v[104:107], v1, s[24:27], s33 offen offset:256 nt
    s_nop 0
    v_mfma_f32_16x16x32_bf16 v[60:63], v[44:47], v[12:15], 0
    v_mfma_f32_16x16x32_bf16 v[60:63], v[44:47], v[16:19], v[60:63]
    v_add_f32_dpp v28, v56, v20 row_ror:4 row_mask:0xf bank_mask:0x2
    v_add_f32_dpp v28, v57, v28 quad_perm:[0,1,2,3] row_mask:0xf bank_mask:0x2
    v_add_f32_dpp v28, v58, v28 row_ror:12 row_mask:0xf bank_mask:0x2
    v_add_f32_dpp v28, v59, v28 row_ror:8 row_mask:0xf bank_mask:0x2
    s_cmp_lg_u32 s54, 0
    s_cbranch_scc1 L_noann
    v_add_u32 v82, 1, v80
    s_getreg_b32 s42, hwreg(HW_REG_XCC_ID, 0, 4)
    v_mov_b32 v83, s42
    s_mov_b64 exec, 1
    global_store_dwordx2 v81, v[82:83], s[48:49] offset:8 sc1
    s_mov_b64 exec, -1
L_noann:
    s_waitcnt vmcnt(5)
    v_cvt_f32_i32 v84, v84
    v_cvt_f32_i32 v85, v85
    v_cvt_f32_i32 v86, v86
    v_cvt_f32_i32 v87, v87
    v_cvt_pk_bf16_f32 v40, v84, v85
    v_cvt_pk_bf16_f32 v41, v86, v87
    s_add_u32 s33, s32, 73728
    buffer_load_dwordx4 v[108:111], v1, s[24:27], s33 offen offset:0 nt
    s_waitcnt vmcnt(5)
    v_cvt_f32_i32 v88, v88
    v_cvt_f32_i32 v89, v89
    v_cvt_f32_i32 v90, v90
    v_cvt_f32_i32 v91, v91
    v_cvt_pk_bf16_f32 v42, v88, v89
    v_cvt_pk_bf16_f32 v43, v90, v91
    buffer_load_dwordx4 v[112:115], v1, s[24:27], s33 offen offset:256 nt
    s_nop 0
    v_mfma_f32_16x16x32_bf16 v[64:67], v[40:43], v[12:15], 0
    v_mfma_f32_16x16x32_bf16 v[64:67], v[40:43], v[16:19], v[64:67]
    v_add_f32_dpp v29, v60, v20 row_ror:4 row_mask:0xf bank_mask:0x2
    v_add_f32_dpp v29, v61, v29 quad_perm:[0,1,2,3] row_mask:0xf bank_mask:0x2
    v_add_f32_dpp v29, v62, v29 row_ror:12 row_mask:0xf bank_mask:0x2
    v_add_f32_dpp v29, v63, v29 row_ror:8 row_mask:0xf bank_mask:0x2
    s_waitcnt vmcnt(5)
    v_cvt_f32_i32 v92, v92
    v_cvt_f32_i32 v93, v93
    v_cvt_f32_i32 v94, v94
    v_cvt_f32_i32 v95, v95
    v_cvt_pk_bf16_f32 v44, v92, v93
    v_cvt_pk_bf16_f32 v45, v94, v95
    s_add_u32 s33, s32, 81920
    buffer_load_dwordx4 v[116:119], v1, s[24:27], s33 offen offset:0 nt
    s_waitcnt vmcnt(5)
    v_cvt_f32_i32 v96, v96
    v_cvt_f32_i32 v97, v97
    v_cvt_f32_i32 v98, v98
    v_cvt_f32_i32 v99, v99
    v_cvt_pk_bf16_f32 v46, v96, v97
    v_cvt_pk_bf16_f32 v47, v98, v99
    buffer_load_dwordx4 v[120:123], v1, s[24:27], s33 offen offset:256 nt
    s_nop 0
    v_mfma_f32_16x16x32_bf16 v[68:71], v[44:47], v[12:15], 0
    v_mfma_f32_16x16x32_bf16 v[68:71], v[44:47], v[16:19], v[68:71]
    v_add_f32_dpp v30, v64, v20 row_ror:4 row_mask:0xf bank_mask:0x2
    v_add_f32_dpp v30, v65, v30 quad_perm:[0,1,2,3] row_mask:0xf bank_mask:0x2
    v_add_f32_dpp v30, v66, v30 row_ror:12 row_mask:0xf bank_mask:0x2
    v_add_f32_dpp v30, v67, v30 row_ror:8 row_mask:0xf bank_mask:0x2
    s_waitcnt vmcnt(5)
    v_cvt_f32_i32 v100, v100
    v_cvt_f32_i32 v101, v101
    v_cvt_f32_i32 v102, v102
    v_cvt_f32_i32 v103, v103
    v_cvt_pk_bf16_f32 v40, v100, v101
    v_cvt_pk_bf16_f32 v41, v102, v103
    s_add_u32 s33, s32, 90112
    buffer_load_dwordx4 v[124:127], v1, s[24:27], s33 offen offset:0 nt
    s_waitcnt vmcnt(5)
    v_cvt_f32_i32 v104, v104
    v_cvt_f32_i32 v105, v105
    v_cvt_f32_i32 v106, v106
    v_cvt_f32_i32 v107, v107
    v_cvt_pk_bf16_f32 v42, v104, v105
    v_cvt_pk_bf16_f32 v43, v106, v107
    buffer_load_dwordx4 v[128:131], v1, s[24:27], s33 offen offset:256 nt
    s_nop 0
    v_mfma_f32_16x16x32_bf16 v[56:59], v[40:43], v[12:15], 0
    v_mfma_f32_16x16x32_bf16 v[56:59], v[40:43], v[16:19], v[56:59]
    v_add_f32_dpp v31, v68, v20 row_ror:4 row_mask:0xf bank_mask:0x2
    v_add_f32_dpp v31, v69, v31 quad_perm:[0,1,2,3] row_mask:0xf bank_mask:0x2
    v_add_f32_dpp v31, v70, v31 row_ror:12 row_mask:0xf bank_mask:0x2
    v_add_f32_dpp v31, v71, v31 row_ror:8 row_mask:0xf bank_mask:0x2
    global_load_ushort v36, v11, s[14:15] offset:0
    global_load_ushort v38, v11, s[16:17] offset:0
    global_load_ushort v37, v11, s[14:15] offset:512
    global_load_ushort v39, v11, s[16:17] offset:512
    s_waitcnt vmcnt(9)
    v_cvt_f32_i32 v108, v108
    v_cvt_f32_i32 v109, v109
    v_cvt_f32_i32 v110, v110
    v_cvt_f32_i32 v111, v111
    v_cvt_pk_bf16_f32 v44, v108, v109
    v_cvt_pk_bf16_f32 v45, v110, v111
    s_add_u32 s33, s32, 98304
    buffer_load_dwordx4 v[84:87], v1, s[24:27], s33 offen offset:0 nt
    s_waitcnt vmcnt(9)
    v_cvt_f32_i32 v112, v112
    v_cvt_f32_i32 v113, v113
    v_cvt_f32_i32 v114, v114
    v_cvt_f32_i32 v115, v115
    v_cvt_pk_bf16_f32 v46, v112, v113
    v_cvt_pk_bf16_f32 v47, v114, v115
    buffer_load_dwordx4 v[88:91], v1, s[24:27], s33 offen offset:256 nt
    s_nop 0
    v_mfma_f32_16x16x32_bf16 v[60:63], v[44:47], v[12:15], 0
    v_mfma_f32_16x16x32_bf16 v[60:63], v[44:47], v[16:19], v[60:63]
    v_add_f32_dpp v28, v56, v20 row_ror:8 row_mask:0xf bank_mask:0x4
    v_add_f32_dpp v28, v57, v28 row_ror:4 row_mask:0xf bank_mask:0x4
    v_add_f32_dpp v28, v58, v28 quad_perm:[0,1,2,3] row_mask:0xf bank_mask:0x4
    v_add_f32_dpp v28, v59, v28 row_ror:12 row_mask:0xf bank_mask:0x4
    s_waitcnt vmcnt(9)
    v_cvt_f32_i32 v116, v116
    v_cvt_f32_i32 v117, v117
    v_cvt_f32_i32 v118, v118
    v_cvt_f32_i32 v119, v119
    v_cvt_pk_bf16_f32 v40, v116, v117
    v_cvt_pk_bf16_f32 v41, v118, v119
    s_add_u32 s33, s32, 106496
    buffer_load_dwordx4 v[92:95], v1, s[24:27], s33 offen offset:0 nt
    s_waitcnt vmcnt(9)
    v_cvt_f32_i32 v120, v120
    v_cvt_f32_i32 v121, v121
    v_cvt_f32_i32 v122, v122
    v_cvt_f32_i32 v123, v123
    v_cvt_pk_bf16_f32 v42, v120, v121
    v_cvt_pk_bf16_f32 v43, v122, v123
    buffer_load_dwordx4 v[96:99], v1, s[24:27], s33 offen offset:256 nt
    s_nop 0
    v_mfma_f32_16x16x32_bf16 v[64:67], v[40:43], v[12:15], 0
    v_mfma_f32_16x16x32_bf16 v[64:67], v[40:43], v[16:19], v[64:67]
    v_add_f32_dpp v29, v60, v20 row_ror:8 row_mask:0xf bank_mask:0x4
    v_add_f32_dpp v29, v61, v29 row_ror:4 row_mask:0xf bank_mask:0x4
    v_add_f32_dpp v29, v62, v29 quad_perm:[0,1,2,3] row_mask:0xf bank_mask:0x4
    v_add_f32_dpp v29, v63, v29 row_ror:12 row_mask:0xf bank_mask:0x4
    s_waitcnt vmcnt(9)
    v_cvt_f32_i32 v124, v124
    v_cvt_f32_i32 v125, v125
    v_cvt_f32_i32 v126, v126
    v_cvt_f32_i32 v127, v127
    v_cvt_pk_bf16_f32 v44, v124, v125
    v_cvt_pk_bf16_f32 v45, v126, v127
    s_add_u32 s33, s32, 114688
    buffer_load_dwordx4 v[100:103], v1, s[24:27], s33 offen offset:0 nt
    s_waitcnt vmcnt(9)
    v_cvt_f32_i32 v128, v128
    v_cvt_f32_i32 v129, v129
    v_cvt_f32_i32 v130, v130
    v_cvt_f32_i32 v131, v131
    v_cvt_pk_bf16_f32 v46, v128, v129
    v_cvt_pk_bf16_f32 v47, v130, v131
    buffer_load_dwordx4 v[104:107], v1, s[24:27], s33 offen offset:256 nt
    s_nop 0
    v_mfma_f32_16x16x32_bf16 v[68:71], v[44:47], v[12:15], 0
    v_mfma_f32_16x16x32_bf16 v[68:71], v[44:47], v[16:19], v[68:71]
    v_add_f32_dpp v30, v64, v20 row_ror:8 row_mask:0xf bank_mask:0x4
    v_add_f32_dpp v30, v65, v30 row_ror:4 row_mask:0xf bank_mask:0x4
    v_add_f32_dpp v30, v66, v30 quad_perm:[0,1,2,3] row_mask:0xf bank_mask:0x4
    v_add_f32_dpp v30, v67, v30 row_ror:12 row_mask:0xf bank_mask:0x4
    s_waitcnt vmcnt(5)
    v_cvt_f32_i32 v84, v84
    v_cvt_f32_i32 v85, v85
    v_cvt_f32_i32 v86, v86
    v_cvt_f32_i32 v87, v87
    v_cvt_pk_bf16_f32 v40, v84, v85
    v_cvt_pk_bf16_f32 v41, v86, v87
    s_add_u32 s33, s32, 122880
    buffer_load_dwordx4 v[108:111], v1, s[24:27], s33 offen offset:0 nt
    s_waitcnt vmcnt(5)
    v_cvt_f32_i32 v88, v88
    v_cvt_f32_i32 v89, v89
    v_cvt_f32_i32 v90, v90
    v_cvt_f32_i32 v91, v91
    v_cvt_pk_bf16_f32 v42, v88, v89
    v_cvt_pk_bf16_f32 v43, v90, v91
    buffer_load_dwordx4 v[112:115], v1, s[24:27], s33 offen offset:256 nt
    s_nop 0
    v_mfma_f32_16x16x32_bf16 v[56:59], v[40:43], v[12:15], 0
    v_mfma_f32_16x16x32_bf16 v[56:59], v[40:43], v[16:19], v[56:59]
    v_add_f32_dpp v31, v68, v20 row_ror:8 row_mask:0xf bank_mask:0x4
    v_add_f32_dpp v31, v69, v31 row_ror:4 row_mask:0xf bank_mask:0x4
    v_add_f32_dpp v31, v70, v31 quad_perm:[0,1,2,3] row_mask:0xf bank_mask:0x4
    v_add_f32_dpp v31, v71, v31 row_ror:12 row_mask:0xf bank_mask:0x4
    s_waitcnt vmcnt(5)
    v_cvt_f32_i32 v92, v92
    v_cvt_f32_i32 v93, v93
    v_cvt_f32_i32 v94, v94
    v_cvt_f32_i32 v95, v95
    v_cvt_pk_bf16_f32 v44, v92, v93
    v_cvt_pk_bf16_f32 v45, v94, v95
    s_add_u32 s33, s32, 131072
    buffer_load_dwordx4 v[116:119], v1, s[24:27], s33 offen offset:0 nt
    s_waitcnt vmcnt(5)
    v_cvt_f32_i32 v96, v96
    v_cvt_f32_i32 v97, v97
    v_cvt_f32_i32 v98, v98
    v_cvt_f32_i32 v99, v99
    v_cvt_pk_bf16_f32 v46, v96, v97
    v_cvt_pk_bf16_f32 v47, v98, v99
    buffer_load_dwordx4 v[120:123], v1, s[24:27], s33 offen offset:256 nt
    s_nop 0
    v_mfma_f32_16x16x32_bf16 v[60:63], v[44:47], v[12:15], 0
    v_mfma_f32_16x16x32_bf16 v[60:63], v[44:47], v[16:19], v[60:63]
    v_add_f32_dpp v28, v56, v20 row_ror:12 row_mask:0xf bank_mask:0x8
    v_add_f32_dpp v28, v57, v28 row_ror:8 row_mask:0xf bank_mask:0x8
    v_add_f32_dpp v28, v58, v28 row_ror:4 row_mask:0xf bank_mask:0x8
    v_add_f32_dpp v28, v59, v28 quad_perm:[0,1,2,3] row_mask:0xf bank_mask:0x8
    s_waitcnt vmcnt(5)
    v_cvt_f32_i32 v100, v100
    v_cvt_f32_i32 v101, v101
    v_cvt_f32_i32 v102, v102
    v_cvt_f32_i32 v103, v103
    v_cvt_pk_bf16_f32 v40, v100, v101
    v_cvt_pk_bf16_f32 v41, v102, v103
    s_add_u32 s33, s32, 139264
    buffer_load_dwordx4 v[124:127], v1, s[24:27], s33 offen offset:0 nt
    s_waitcnt vmcnt(5)
    v_cvt_f32_i32 v104, v104
    v_cvt_f32_i32 v105, v105
    v_cvt_f32_i32 v106, v106
    v_cvt_f32_i32 v107, v107
    v_cvt_pk_bf16_f32 v42, v104, v105
    v_cvt_pk_bf16_f32 v43, v106, v107
    buffer_load_dwordx4 v[128:131], v1, s[24:27], s33 offen offset:256 nt
    s_nop 0
    v_mfma_f32_16x16x32_bf16 v[64:67], v[40:43], v[12:15], 0
    v_mfma_f32_16x16x32_bf16 v[64:67], v[40:43], v[16:19], v[64:67]
    v_add_f32_dpp v29, v60, v20 row_ror:12 row_mask:0xf bank_mask:0x8
    v_add_f32_dpp v29, v61, v29 row_ror:8 row_mask:0xf bank_mask:0x8
    v_add_f32_dpp v29, v62, v29 row_ror:4 row_mask:0xf bank_mask:0x8
    v_add_f32_dpp v29, v63, v29 quad_perm:[0,1,2,3] row_mask:0xf bank_mask:0x8
    s_waitcnt vmcnt(5)
    v_cvt_f32_i32 v108, v108
    v_cvt_f32_i32 v109, v109
    v_cvt_f32_i32 v110, v110
    v_cvt_f32_i32 v111, v111
    v_cvt_pk_bf16_f32 v44, v108, v109
    v_cvt_pk_bf16_f32 v45, v110, v111
    s_add_u32 s33, s32, 147456
    buffer_load_dwordx4 v[84:87], v1, s[24:27], s33 offen offset:0 nt
    s_waitcnt vmcnt(5)
    v_cvt_f32_i32 v112, v112
    v_cvt_f32_i32 v113, v113
    v_cvt_f32_i32 v114, v114
    v_cvt_f32_i32 v115, v115
    v_cvt_pk_bf16_f32 v46, v112, v113
    v_cvt_pk_bf16_f32 v47, v114, v115
    buffer_load_dwordx4 v[88:91], v1, s[24:27], s33 offen offset:256 nt
    s_nop 0
    v_mfma_f32_16x16x32_bf16 v[68:71], v[44:47], v[12:15], 0
    v_mfma_f32_16x16x32_bf16 v[68:71], v[44:47], v[16:19], v[68:71]
    v_add_f32_dpp v30, v64, v20 row_ror:12 row_mask:0xf bank_mask:0x8
    v_add_f32_dpp v30, v65, v30 row_ror:8 row_mask:0xf bank_mask:0x8
    v_add_f32_dpp v30, v66, v30 row_ror:4 row_mask:0xf bank_mask:0x8
    v_add_f32_dpp v30, v67, v30 quad_perm:[0,1,2,3] row_mask:0xf bank_mask:0x8
    s_waitcnt vmcnt(5)
    v_cvt_f32_i32 v116, v116
    v_cvt_f32_i32 v117, v117
    v_cvt_f32_i32 v118, v118
    v_cvt_f32_i32 v119, v119
    v_cvt_pk_bf16_f32 v40, v116, v117
    v_cvt_pk_bf16_f32 v41, v118, v119
    s_add_u32 s33, s32, 155648
    buffer_load_dwordx4 v[92:95], v1, s[24:27], s33 offen offset:0 nt
    s_waitcnt vmcnt(5)
    v_cvt_f32_i32 v120, v120
    v_cvt_f32_i32 v121, v121
    v_cvt_f32_i32 v122, v122
    v_cvt_f32_i32 v123, v123
    v_cvt_pk_bf16_f32 v42, v120, v121
    v_cvt_pk_bf16_f32 v43, v122, v123
    buffer_load_dwordx4 v[96:99], v1, s[24:27], s33 offen offset:256 nt
    s_nop 0
    v_mfma_f32_16x16x32_bf16 v[56:59], v[40:43], v[12:15], 0
    v_mfma_f32_16x16x32_bf16 v[56:59], v[40:43], v[16:19], v[56:59]
    v_add_f32_dpp v31, v68, v20 row_ror:12 row_mask:0xf bank_mask:0x8
    v_add_f32_dpp v31, v69, v31 row_ror:8 row_mask:0xf bank_mask:0x8
    v_add_f32_dpp v31, v70, v31 row_ror:4 row_mask:0xf bank_mask:0x8
    v_add_f32_dpp v31, v71, v31 quad_perm:[0,1,2,3] row_mask:0xf bank_mask:0x8
    s_waitcnt vmcnt(5)
    v_cvt_f32_i32 v124, v124
    v_cvt_f32_i32 v125, v125
    v_cvt_f32_i32 v126, v126
    v_cvt_f32_i32 v127, v127
    v_cvt_pk_bf16_f32 v44, v124, v125
    v_cvt_pk_bf16_f32 v45, v126, v127
    s_add_u32 s33, s32, 163840
    buffer_load_dwordx4 v[100:103], v1, s[24:27], s33 offen offset:0 nt
    s_waitcnt vmcnt(5)
    v_cvt_f32_i32 v128, v128
    v_cvt_f32_i32 v129, v129
    v_cvt_f32_i32 v130, v130
    v_cvt_f32_i32 v131, v131
    v_cvt_pk_bf16_f32 v46, v128, v129
    v_cvt_pk_bf16_f32 v47, v130, v131
    buffer_load_dwordx4 v[104:107], v1, s[24:27], s33 offen offset:256 nt
    s_nop 0
    v_mfma_f32_16x16x32_bf16 v[60:63], v[44:47], v[12:15], 0
    v_mfma_f32_16x16x32_bf16 v[60:63], v[44:47], v[16:19], v[60:63]
    v_add_f32_dpp v32, v56, v20 quad_perm:[0,1,2,3] row_mask:0xf bank_mask:0x1
    v_add_f32_dpp v32, v57, v32 row_ror:12 row_mask:0xf bank_mask:0x1
    v_add_f32_dpp v32, v58, v32 row_ror:8 row_mask:0xf bank_mask:0x1
    v_add_f32_dpp v32, v59, v32 row_ror:4 row_mask:0xf bank_mask:0x1
    s_waitcnt vmcnt(5)
    v_cvt_f32_i32 v84, v84
    v_cvt_f32_i32 v85, v85
    v_cvt_f32_i32 v86, v86
    v_cvt_f32_i32 v87, v87
    v_cvt_pk_bf16_f32 v40, v84, v85
    v_cvt_pk_bf16_f32 v41, v86, v87
    s_add_u32 s33, s32, 172032
    buffer_load_dwordx4 v[108:111], v1, s[24:27], s33 offen offset:0 nt
    s_waitcnt vmcnt(5)
    v_cvt_f32_i32 v88, v88
    v_cvt_f32_i32 v89, v89
    v_cvt_f32_i32 v90, v90
    v_cvt_f32_i32 v91, v91
    v_cvt_pk_bf16_f32 v42, v88, v89
    v_cvt_pk_bf16_f32 v43, v90, v91
    buffer_load_dwordx4 v[112:115], v1, s[24:27], s33 offen offset:256 nt
    s_nop 0
    v_mfma_f32_16x16x32_bf16 v[64:67], v[40:43], v[12:15], 0
    v_mfma_f32_16x16x32_bf16 v[64:67], v[40:43], v[16:19], v[64:67]
    v_add_f32_dpp v33, v60, v20 quad_perm:[0,1,2,3] row_mask:0xf bank_mask:0x1
    v_add_f32_dpp v33, v61, v33 row_ror:12 row_mask:0xf bank_mask:0x1
    v_add_f32_dpp v33, v62, v33 row_ror:8 row_mask:0xf bank_mask:0x1
    v_add_f32_dpp v33, v63, v33 row_ror:4 row_mask:0xf bank_mask:0x1
    s_waitcnt vmcnt(5)
    v_cvt_f32_i32 v92, v92
    v_cvt_f32_i32 v93, v93
    v_cvt_f32_i32 v94, v94
    v_cvt_f32_i32 v95, v95
    v_cvt_pk_bf16_f32 v44, v92, v93
    v_cvt_pk_bf16_f32 v45, v94, v95
    s_add_u32 s33, s32, 180224
    buffer_load_dwordx4 v[116:119], v1, s[24:27], s33 offen offset:0 nt
    s_waitcnt vmcnt(5)
    v_cvt_f32_i32 v96, v96
    v_cvt_f32_i32 v97, v97
    v_cvt_f32_i32 v98, v98
    v_cvt_f32_i32 v99, v99
    v_cvt_pk_bf16_f32 v46, v96, v97
    v_cvt_pk_bf16_f32 v47, v98, v99
    buffer_load_dwordx4 v[120:123], v1, s[24:27], s33 offen offset:256 nt
    s_nop 0
    v_mfma_f32_16x16x32_bf16 v[68:71], v[44:47], v[12:15], 0
    v_mfma_f32_16x16x32_bf16 v[68:71], v[44:47], v[16:19], v[68:71]
    v_add_f32_dpp v34, v64, v20 quad_perm:[0,1,2,3] row_mask:0xf bank_mask:0x1
    v_add_f32_dpp v34, v65, v34 row_ror:12 row_mask:0xf bank_mask:0x1
    v_add_f32_dpp v34, v66, v34 row_ror:8 row_mask:0xf bank_mask:0x1
    v_add_f32_dpp v34, v67, v34 row_ror:4 row_mask:0xf bank_mask:0x1
    s_waitcnt vmcnt(5)
    v_cvt_f32_i32 v100, v100
    v_cvt_f32_i32 v101, v101
    v_cvt_f32_i32 v102, v102
    v_cvt_f32_i32 v103, v103
    v_cvt_pk_bf16_f32 v40, v100, v101
    v_cvt_pk_bf16_f32 v41, v102, v103
    s_add_u32 s33, s32, 188416
    buffer_load_dwordx4 v[124:127], v1, s[24:27], s33 offen offset:0 nt
    s_waitcnt vmcnt(5)
    v_cvt_f32_i32 v104, v104
    v_cvt_f32_i32 v105, v105
    v_cvt_f32_i32 v106, v106
    v_cvt_f32_i32 v107, v107
    v_cvt_pk_bf16_f32 v42, v104, v105
    v_cvt_pk_bf16_f32 v43, v106, v107
    buffer_load_dwordx4 v[128:131], v1, s[24:27], s33 offen offset:256 nt
    s_nop 0
    v_mfma_f32_16x16x32_bf16 v[56:59], v[40:43], v[12:15], 0
    v_mfma_f32_16x16x32_bf16 v[56:59], v[40:43], v[16:19], v[56:59]
    v_add_f32_dpp v35, v68, v20 quad_perm:[0,1,2,3] row_mask:0xf bank_mask:0x1
    v_add_f32_dpp v35, v69, v35 row_ror:12 row_mask:0xf bank_mask:0x1
    v_add_f32_dpp v35, v70, v35 row_ror:8 row_mask:0xf bank_mask:0x1
    v_add_f32_dpp v35, v71, v35 row_ror:4 row_mask:0xf bank_mask:0x1
    s_waitcnt vmcnt(5)
    v_cvt_f32_i32 v108, v108
    v_cvt_f32_i32 v109, v109
    v_cvt_f32_i32 v110, v110
    v_cvt_f32_i32 v111, v111
    v_cvt_pk_bf16_f32 v44, v108, v109
    v_cvt_pk_bf16_f32 v45, v110, v111
    s_add_u32 s33, s32, 196608
    buffer_load_dwordx4 v[84:87], v1, s[24:27], s33 offen offset:0 nt
    s_waitcnt vmcnt(5)
    v_cvt_f32_i32 v112, v112
    v_cvt_f32_i32 v113, v113
    v_cvt_f32_i32 v114, v114
    v_cvt_f32_i32 v115, v115
    v_cvt_pk_bf16_f32 v46, v112, v113
    v_cvt_pk_bf16_f32 v47, v114, v115
    buffer_load_dwordx4 v[88:91], v1, s[24:27], s33 offen offset:256 nt
    s_nop 0
    v_mfma_f32_16x16x32_bf16 v[60:63], v[44:47], v[12:15], 0
    v_mfma_f32_16x16x32_bf16 v[60:63], v[44:47], v[16:19], v[60:63]
    v_add_f32_dpp v32, v56, v20 row_ror:4 row_mask:0xf bank_mask:0x2
    v_add_f32_dpp v32, v57, v32 quad_perm:[0,1,2,3] row_mask:0xf bank_mask:0x2
    v_add_f32_dpp v32, v58, v32 row_ror:12 row_mask:0xf bank_mask:0x2
    v_add_f32_dpp v32, v59, v32 row_ror:8 row_mask:0xf bank_mask:0x2
    s_waitcnt vmcnt(5)
    v_cvt_f32_i32 v116, v116
    v_cvt_f32_i32 v117, v117
    v_cvt_f32_i32 v118, v118
    v_cvt_f32_i32 v119, v119
    v_cvt_pk_bf16_f32 v40, v116, v117
    v_cvt_pk_bf16_f32 v41, v118, v119
    s_add_u32 s33, s32, 204800
    buffer_load_dwordx4 v[92:95], v1, s[24:27], s33 offen offset:0 nt
    s_waitcnt vmcnt(5)
    v_cvt_f32_i32 v120, v120
    v_cvt_f32_i32 v121, v121
    v_cvt_f32_i32 v122, v122
    v_cvt_f32_i32 v123, v123
    v_cvt_pk_bf16_f32 v42, v120, v121
    v_cvt_pk_bf16_f32 v43, v122, v123
    buffer_load_dwordx4 v[96:99], v1, s[24:27], s33 offen offset:256 nt
    s_nop 0
    v_mfma_f32_16x16x32_bf16 v[64:67], v[40:43], v[12:15], 0
    v_mfma_f32_16x16x32_bf16 v[64:67], v[40:43], v[16:19], v[64:67]
    v_add_f32_dpp v33, v60, v20 row_ror:4 row_mask:0xf bank_mask:0x2
    v_add_f32_dpp v33, v61, v33 quad_perm:[0,1,2,3] row_mask:0xf bank_mask:0x2
    v_add_f32_dpp v33, v62, v33 row_ror:12 row_mask:0xf bank_mask:0x2
    v_add_f32_dpp v33, v63, v33 row_ror:8 row_mask:0xf bank_mask:0x2
    s_waitcnt vmcnt(5)
    v_cvt_f32_i32 v124, v124
    v_cvt_f32_i32 v125, v125
    v_cvt_f32_i32 v126, v126
    v_cvt_f32_i32 v127, v127
    v_cvt_pk_bf16_f32 v44, v124, v125
    v_cvt_pk_bf16_f32 v45, v126, v127
    s_add_u32 s33, s32, 212992
    buffer_load_dwordx4 v[100:103], v1, s[24:27], s33 offen offset:0 nt
    s_waitcnt vmcnt(5)
    v_cvt_f32_i32 v128, v128
    v_cvt_f32_i32 v129, v129
    v_cvt_f32_i32 v130, v130
    v_cvt_f32_i32 v131, v131
    v_cvt_pk_bf16_f32 v46, v128, v129
    v_cvt_pk_bf16_f32 v47, v130, v131
    buffer_load_dwordx4 v[104:107], v1, s[24:27], s33 offen offset:256 nt
    s_nop 0
    v_mfma_f32_16x16x32_bf16 v[68:71], v[44:47], v[12:15], 0
    v_mfma_f32_16x16x32_bf16 v[68:71], v[44:47], v[16:19], v[68:71]
    v_add_f32_dpp v34, v64, v20 row_ror:4 row_mask:0xf bank_mask:0x2
    v_add_f32_dpp v34, v65, v34 quad_perm:[0,1,2,3] row_mask:0xf bank_mask:0x2
    v_add_f32_dpp v34, v66, v34 row_ror:12 row_mask:0xf bank_mask:0x2
    v_add_f32_dpp v34, v67, v34 row_ror:8 row_mask:0xf bank_mask:0x2
    s_waitcnt vmcnt(5)
    v_cvt_f32_i32 v84, v84
    v_cvt_f32_i32 v85, v85
    v_cvt_f32_i32 v86, v86
    v_cvt_f32_i32 v87, v87
    v_cvt_pk_bf16_f32 v40, v84, v85
    v_cvt_pk_bf16_f32 v41, v86, v87
    s_add_u32 s33, s32, 221184
    buffer_load_dwordx4 v[108:111], v1, s[24:27], s33 offen offset:0 nt
    s_waitcnt vmcnt(5)
    v_cvt_f32_i32 v88, v88
    v_cvt_f32_i32 v89, v89
    v_cvt_f32_i32 v90, v90
    v_cvt_f32_i32 v91, v91
    v_cvt_pk_bf16_f32 v42, v88, v89
    v_cvt_pk_bf16_f32 v43, v90, v91
    buffer_load_dwordx4 v[112:115], v1, s[24:27], s33 offen offset:256 nt
    s_nop 0
    v_mfma_f32_16x16x32_bf16 v[56:59], v[40:43], v[12:15], 0
    v_mfma_f32_16x16x32_bf16 v[56:59], v[40:43], v[16:19], v[56:59]
    v_add_f32_dpp v35, v68, v20 row_ror:4 row_mask:0xf bank_mask:0x2
    v_add_f32_dpp v35, v69, v35 quad_perm:[0,1,2,3] row_mask:0xf bank_mask:0x2
    v_add_f32_dpp v35, v70, v35 row_ror:12 row_mask:0xf bank_mask:0x2
    v_add_f32_dpp v35, v71, v35 row_ror:8 row_mask:0xf bank_mask:0x2
    s_waitcnt vmcnt(5)
    v_cvt_f32_i32 v92, v92
    v_cvt_f32_i32 v93, v93
    v_cvt_f32_i32 v94, v94
    v_cvt_f32_i32 v95, v95
    v_cvt_pk_bf16_f32 v44, v92, v93
    v_cvt_pk_bf16_f32 v45, v94, v95
    s_add_u32 s33, s32, 229376
    buffer_load_dwordx4 v[116:119], v1, s[24:27], s33 offen offset:0 nt
    s_waitcnt vmcnt(5)
    v_cvt_f32_i32 v96, v96
    v_cvt_f32_i32 v97, v97
    v_cvt_f32_i32 v98, v98
    v_cvt_f32_i32 v99, v99
    v_cvt_pk_bf16_f32 v46, v96, v97
    v_cvt_pk_bf16_f32 v47, v98, v99
    buffer_load_dwordx4 v[120:123], v1, s[24:27], s33 offen offset:256 nt
    s_nop 0
    v_mfma_f32_16x16x32_bf16 v[60:63], v[44:47], v[12:15], 0
    v_mfma_f32_16x16x32_bf16 v[60:63], v[44:47], v[16:19], v[60:63]
    v_add_f32_dpp v32, v56, v20 row_ror:8 row_mask:0xf bank_mask:0x4
    v_add_f32_dpp v32, v57, v32 row_ror:4 row_mask:0xf bank_mask:0x4
    v_add_f32_dpp v32, v58, v32 quad_perm:[0,1,2,3] row_mask:0xf bank_mask:0x4
    v_add_f32_dpp v32, v59, v32 row_ror:12 row_mask:0xf bank_mask:0x4
    s_waitcnt vmcnt(5)
    v_cvt_f32_i32 v100, v100
    v_cvt_f32_i32 v101, v101
    v_cvt_f32_i32 v102, v102
    v_cvt_f32_i32 v103, v103
    v_cvt_pk_bf16_f32 v40, v100, v101
    v_cvt_pk_bf16_f32 v41, v102, v103
    s_add_u32 s33, s32, 237568
    buffer_load_dwordx4 v[124:127], v1, s[24:27], s33 offen offset:0 nt
    s_waitcnt vmcnt(5)
    v_cvt_f32_i32 v104, v104
    v_cvt_f32_i32 v105, v105
    v_cvt_f32_i32 v106, v106
    v_cvt_f32_i32 v107, v107
    v_cvt_pk_bf16_f32 v42, v104, v105
    v_cvt_pk_bf16_f32 v43, v106, v107
    buffer_load_dwordx4 v[128:131], v1, s[24:27], s33 offen offset:256 nt
    s_nop 0
    v_mfma_f32_16x16x32_bf16 v[64:67], v[40:43], v[12:15], 0
    v_mfma_f32_16x16x32_bf16 v[64:67], v[40:43], v[16:19], v[64:67]
    v_add_f32_dpp v33, v60, v20 row_ror:8 row_mask:0xf bank_mask:0x4
    v_add_f32_dpp v33, v61, v33 row_ror:4 row_mask:0xf bank_mask:0x4
    v_add_f32_dpp v33, v62, v33 quad_perm:[0,1,2,3] row_mask:0xf bank_mask:0x4
    v_add_f32_dpp v33, v63, v33 row_ror:12 row_mask:0xf bank_mask:0x4
    s_waitcnt vmcnt(5)
    v_cvt_f32_i32 v108, v108
    v_cvt_f32_i32 v109, v109
    v_cvt_f32_i32 v110, v110
    v_cvt_f32_i32 v111, v111
    v_cvt_pk_bf16_f32 v44, v108, v109
    v_cvt_pk_bf16_f32 v45, v110, v111
    s_add_u32 s33, s32, 245760
    buffer_load_dwordx4 v[84:87], v1, s[24:27], s33 offen offset:0 nt
    s_waitcnt vmcnt(5)
    v_cvt_f32_i32 v112, v112
    v_cvt_f32_i32 v113, v113
    v_cvt_f32_i32 v114, v114
    v_cvt_f32_i32 v115, v115
    v_cvt_pk_bf16_f32 v46, v112, v113
    v_cvt_pk_bf16_f32 v47, v114, v115
    buffer_load_dwordx4 v[88:91], v1, s[24:27], s33 offen offset:256 nt
    s_nop 0
    v_mfma_f32_16x16x32_bf16 v[68:71], v[44:47], v[12:15], 0
    v_mfma_f32_16x16x32_bf16 v[68:71], v[44:47], v[16:19], v[68:71]
    v_add_f32_dpp v34, v64, v20 row_ror:8 row_mask:0xf bank_mask:0x4
    v_add_f32_dpp v34, v65, v34 row_ror:4 row_mask:0xf bank_mask:0x4
    v_add_f32_dpp v34, v66, v34 quad_perm:[0,1,2,3] row_mask:0xf bank_mask:0x4
    v_add_f32_dpp v34, v67, v34 row_ror:12 row_mask:0xf bank_mask:0x4
    s_waitcnt vmcnt(5)
    v_cvt_f32_i32 v116, v116
    v_cvt_f32_i32 v117, v117
    v_cvt_f32_i32 v118, v118
    v_cvt_f32_i32 v119, v119
    v_cvt_pk_bf16_f32 v40, v116, v117
    v_cvt_pk_bf16_f32 v41, v118, v119
    s_add_u32 s33, s32, 253952
    buffer_load_dwordx4 v[92:95], v1, s[24:27], s33 offen offset:0 nt
    s_waitcnt vmcnt(5)
    v_cvt_f32_i32 v120, v120
    v_cvt_f32_i32 v121, v121
    v_cvt_f32_i32 v122, v122
    v_cvt_f32_i32 v123, v123
    v_cvt_pk_bf16_f32 v42, v120, v121
    v_cvt_pk_bf16_f32 v43, v122, v123
    buffer_load_dwordx4 v[96:99], v1, s[24:27], s33 offen offset:256 nt
    s_nop 0
    v_mfma_f32_16x16x32_bf16 v[56:59], v[40:43], v[12:15], 0
    v_mfma_f32_16x16x32_bf16 v[56:59], v[40:43], v[16:19], v[56:59]
    v_add_f32_dpp v35, v68, v20 row_ror:8 row_mask:0xf bank_mask:0x4
    v_add_f32_dpp v35, v69, v35 row_ror:4 row_mask:0xf bank_mask:0x4
    v_add_f32_dpp v35, v70, v35 quad_perm:[0,1,2,3] row_mask:0xf bank_mask:0x4
    v_add_f32_dpp v35, v71, v35 row_ror:12 row_mask:0xf bank_mask:0x4
    s_waitcnt vmcnt(5)
    v_cvt_f32_i32 v124, v124
    v_cvt_f32_i32 v125, v125
    v_cvt_f32_i32 v126, v126
    v_cvt_f32_i32 v127, v127
    v_cvt_pk_bf16_f32 v44, v124, v125
    v_cvt_pk_bf16_f32 v45, v126, v127
    s_add_u32 s33, s32, 0
    buffer_load_dwordx4 v[100:103], v2, s[28:31], s33 offen offset:0 nt
    s_waitcnt vmcnt(5)
    v_cvt_f32_i32 v128, v128
    v_cvt_f32_i32 v129, v129
    v_cvt_f32_i32 v130, v130
    v_cvt_f32_i32 v131, v131
    v_cvt_pk_bf16_f32 v46, v128, v129
    v_cvt_pk_bf16_f32 v47, v130, v131
    buffer_load_dwordx4 v[104:107], v2, s[28:31], s33 offen offset:1024 nt
    s_nop 0
    v_mfma_f32_16x16x32_bf16 v[60:63], v[44:47], v[12:15], 0
    v_mfma_f32_16x16x32_bf16 v[60:63], v[44:47], v[16:19], v[60:63]
    v_add_f32_dpp v32, v56, v20 row_ror:12 row_mask:0xf bank_mask:0x8
    v_add_f32_dpp v32, v57, v32 row_ror:8 row_mask:0xf bank_mask:0x8
    v_add_f32_dpp v32, v58, v32 row_ror:4 row_mask:0xf bank_mask:0x8
    v_add_f32_dpp v32, v59, v32 quad_perm:[0,1,2,3] row_mask:0xf bank_mask:0x8
    s_waitcnt vmcnt(5)
    v_cvt_f32_i32 v84, v84
    v_cvt_f32_i32 v85, v85
    v_cvt_f32_i32 v86, v86
    v_cvt_f32_i32 v87, v87
    v_cvt_pk_bf16_f32 v40, v84, v85
    v_cvt_pk_bf16_f32 v41, v86, v87
    s_add_u32 s33, s32, 8192
    buffer_load_dwordx4 v[108:111], v2, s[28:31], s33 offen offset:0 nt
    s_waitcnt vmcnt(5)
    v_cvt_f32_i32 v88, v88
    v_cvt_f32_i32 v89, v89
    v_cvt_f32_i32 v90, v90
    v_cvt_f32_i32 v91, v91
    v_cvt_pk_bf16_f32 v42, v88, v89
    v_cvt_pk_bf16_f32 v43, v90, v91
    buffer_load_dwordx4 v[112:115], v2, s[28:31], s33 offen offset:1024 nt
    s_nop 0
    v_mfma_f32_16x16x32_bf16 v[64:67], v[40:43], v[12:15], 0
    v_mfma_f32_16x16x32_bf16 v[64:67], v[40:43], v[16:19], v[64:67]
    v_add_f32_dpp v33, v60, v20 row_ror:12 row_mask:0xf bank_mask:0x8
    v_add_f32_dpp v33, v61, v33 row_ror:8 row_mask:0xf bank_mask:0x8
    v_add_f32_dpp v33, v62, v33 row_ror:4 row_mask:0xf bank_mask:0x8
    v_add_f32_dpp v33, v63, v33 quad_perm:[0,1,2,3] row_mask:0xf bank_mask:0x8
    s_waitcnt vmcnt(5)
    v_cvt_f32_i32 v92, v92
    v_cvt_f32_i32 v93, v93
    v_cvt_f32_i32 v94, v94
    v_cvt_f32_i32 v95, v95
    v_cvt_pk_bf16_f32 v44, v92, v93
    v_cvt_pk_bf16_f32 v45, v94, v95
    s_add_u32 s33, s32, 16384
    buffer_load_dwordx4 v[116:119], v2, s[28:31], s33 offen offset:0 nt
    s_waitcnt vmcnt(5)
    v_cvt_f32_i32 v96, v96
    v_cvt_f32_i32 v97, v97
    v_cvt_f32_i32 v98, v98
    v_cvt_f32_i32 v99, v99
    v_cvt_pk_bf16_f32 v46, v96, v97
    v_cvt_pk_bf16_f32 v47, v98, v99
    buffer_load_dwordx4 v[120:123], v2, s[28:31], s33 offen offset:1024 nt
    s_nop 0
    v_mfma_f32_16x16x32_bf16 v[68:71], v[44:47], v[12:15], 0
    v_mfma_f32_16x16x32_bf16 v[68:71], v[44:47], v[16:19], v[68:71]
    v_add_f32_dpp v34, v64, v20 row_ror:12 row_mask:0xf bank_mask:0x8
    v_add_f32_dpp v34, v65, v34 row_ror:8 row_mask:0xf bank_mask:0x8
    v_add_f32_dpp v34, v66, v34 row_ror:4 row_mask:0xf bank_mask:0x8
    v_add_f32_dpp v34, v67, v34 quad_perm:[0,1,2,3] row_mask:0xf bank_mask:0x8
    s_nop 7
    v_add_f32_dpp v35, v68, v20 row_ror:12 row_mask:0xf bank_mask:0x8
    v_add_f32_dpp v35, v69, v35 row_ror:8 row_mask:0xf bank_mask:0x8
    v_add_f32_dpp v35, v70, v35 row_ror:4 row_mask:0xf bank_mask:0x8
    v_add_f32_dpp v35, v71, v35 quad_perm:[0,1,2,3] row_mask:0xf bank_mask:0x8
    v_max3_f32 v24, v28, v29, v30
    v_max3_f32 v24, v24, v31, v32
    v_max3_f32 v24, v24, v33, v34
    v_max_f32 v24, v24, v35
    s_nop 1
    v_max_f32_dpp v24, v24, v24 row_ror:4 row_mask:0xf bank_mask:0xf
    s_nop 1
    v_max_f32_dpp v24, v24, v24 row_ror:8 row_mask:0xf bank_mask:0xf
    v_mov_b32 v3, v24
    s_nop 1
    v_permlane16_swap_b32 v3, v24
    v_max_f32 v24, v24, v3
    v_mov_b32 v3, v24
    s_nop 1
    v_permlane32_swap_b32 v3, v24
    v_max_f32 v24, v24, v3
    v_sub_f32 v28, v28, v24
    v_sub_f32 v29, v29, v24
    v_sub_f32 v30, v30, v24
    v_sub_f32 v31, v31, v24
    v_sub_f32 v32, v32, v24
    v_sub_f32 v33, v33, v24
    v_sub_f32 v34, v34, v24
    v_sub_f32 v35, v35, v24
    v_exp_f32 v28, v28
    v_exp_f32 v29, v29
    v_exp_f32 v30, v30
    v_exp_f32 v31, v31
    v_exp_f32 v32, v32
    v_exp_f32 v33, v33
    v_exp_f32 v34, v34
    v_exp_f32 v35, v35
    v_lshlrev_b32 v36, 16, v36
    v_lshlrev_b32 v38, 16, v38
    v_lshlrev_b32 v37, 16, v37
    v_lshlrev_b32 v39, 16, v39
    v_add_f32 v25, v28, v29
    v_add_f32 v25, v25, v30
    v_add_f32 v25, v25, v31
    v_add_f32 v25, v25, v32
    v_add_f32 v25, v25, v33
    v_add_f32 v25, v25, v34
    v_add_f32 v25, v25, v35
    v_mul_f32_dpp v28, v36, v28 quad_perm:[0,0,0,0] row_mask:0xf bank_mask:0xf
    v_mul_f32_dpp v29, v36, v29 quad_perm:[1,1,1,1] row_mask:0xf bank_mask:0xf
    v_mul_f32_dpp v30, v36, v30 quad_perm:[2,2,2,2] row_mask:0xf bank_mask:0xf
    v_mul_f32_dpp v31, v36, v31 quad_perm:[3,3,3,3] row_mask:0xf bank_mask:0xf
    v_mul_f32_dpp v32, v37, v32 quad_perm:[0,0,0,0] row_mask:0xf bank_mask:0xf
    v_mul_f32_dpp v33, v37, v33 quad_perm:[1,1,1,1] row_mask:0xf bank_mask:0xf
    v_mul_f32_dpp v34, v37, v34 quad_perm:[2,2,2,2] row_mask:0xf bank_mask:0xf
    v_mul_f32_dpp v35, v37, v35 quad_perm:[3,3,3,3] row_mask:0xf bank_mask:0xf
    s_mov_b32 s43, 0xffff0000
    v_bfe_u32 v4, v0, 2, 2
    v_lshlrev_b32 v4, 6, v4
    v_bfe_u32 v5, v0, 4, 1
    v_lshl_or_b32 v4, v5, 5, v4
    v_and_b32 v5, 3, v0
    v_lshl_or_b32 v4, v5, 3, v4
    v_lshrrev_b32 v5, 5, v0
    v_lshl_or_b32 v4, v5, 2, v4
    s_lshl_b32 s42, s3, 11
    v_add_u32 v4, s42, v4
    v_cvt_pk_bf16_f32 v72, v28, v29
    v_cvt_pk_bf16_f32 v73, v30, v31
    v_lshlrev_b32 v7, 16, v72
    v_and_b32 v8, s43, v72
    v_lshlrev_b32 v9, 16, v73
    v_and_b32 v10, s43, v73
    v_sub_f32 v28, v28, v7
    v_sub_f32 v29, v29, v8
    v_sub_f32 v30, v30, v9
    v_sub_f32 v31, v31, v10
    v_cvt_pk_bf16_f32 v74, v28, v29
    v_cvt_pk_bf16_f32 v75, v30, v31
    v_lshlrev_b32 v40, 16, v74
    v_and_b32 v41, s43, v74
    v_lshlrev_b32 v42, 16, v75
    v_and_b32 v43, s43, v75
    v_add_f32 v28, v40, v7
    v_add_f32 v29, v41, v8
    v_add_f32 v30, v42, v9
    v_add_f32 v31, v43, v10
    v_mul_f32_dpp v26, v38, v28 quad_perm:[0,0,0,0] row_mask:0xf bank_mask:0xf
    v_fmac_f32_dpp v26, v38, v29 quad_perm:[1,1,1,1] row_mask:0xf bank_mask:0xf
    v_fmac_f32_dpp v26, v38, v30 quad_perm:[2,2,2,2] row_mask:0xf bank_mask:0xf
    v_fmac_f32_dpp v26, v38, v31 quad_perm:[3,3,3,3] row_mask:0xf bank_mask:0xf
    v_permlane32_swap_b32 v7, v8
    v_permlane32_swap_b32 v9, v10
    v_cvt_pk_bf16_f32 v7, v7, v8
    v_cvt_pk_bf16_f32 v9, v9, v10
    ds_write_b32 v4, v7 offset:0
    ds_write_b32 v4, v9 offset:256
    v_permlane32_swap_b32 v40, v41
    v_permlane32_swap_b32 v42, v43
    v_cvt_pk_bf16_f32 v40, v40, v41
    v_cvt_pk_bf16_f32 v42, v42, v43
    ds_write_b32 v4, v40 offset:1024
    ds_write_b32 v4, v42 offset:1280
    v_cvt_pk_bf16_f32 v72, v32, v33
    v_cvt_pk_bf16_f32 v73, v34, v35
    v_lshlrev_b32 v7, 16, v72
    v_and_b32 v8, s43, v72
    v_lshlrev_b32 v9, 16, v73
    v_and_b32 v10, s43, v73
    v_sub_f32 v32, v32, v7
    v_sub_f32 v33, v33, v8
    v_sub_f32 v34, v34, v9
    v_sub_f32 v35, v35, v10
    v_cvt_pk_bf16_f32 v74, v32, v33
    v_cvt_pk_bf16_f32 v75, v34, v35
    v_lshlrev_b32 v40, 16, v74
    v_and_b32 v41, s43, v74
    v_lshlrev_b32 v42, 16, v75
    v_and_b32 v43, s43, v75
    v_add_f32 v32, v40, v7
    v_add_f32 v33, v41, v8
    v_add_f32 v34, v42, v9
    v_add_f32 v35, v43, v10
    v_fmac_f32_dpp v26, v39, v32 quad_perm:[0,0,0,0] row_mask:0xf bank_mask:0xf
    v_fmac_f32_dpp v26, v39, v33 quad_perm:[1,1,1,1] row_mask:0xf bank_mask:0xf
    v_fmac_f32_dpp v26, v39, v34 quad_perm:[2,2,2,2] row_mask:0xf bank_mask:0xf
    v_fmac_f32_dpp v26, v39, v35 quad_perm:[3,3,3,3] row_mask:0xf bank_mask:0xf
    v_permlane32_swap_b32 v7, v8
    v_permlane32_swap_b32 v9, v10
    v_cvt_pk_bf16_f32 v7, v7, v8
    v_cvt_pk_bf16_f32 v9, v9, v10
    ds_write_b32 v4, v7 offset:512
    ds_write_b32 v4, v9 offset:768
    v_permlane32_swap_b32 v40, v41
    v_permlane32_swap_b32 v42, v43
    v_cvt_pk_bf16_f32 v40, v40, v41
    v_cvt_pk_bf16_f32 v42, v42, v43
    ds_write_b32 v4, v40 offset:1536
    ds_write_b32 v4, v42 offset:1792
    v_mov_b32 v3, 0
    global_load_dwordx4 v[80:83], v3, s[48:49]
    s_cmp_lg_u32 s41, 7
    s_cbranch_scc1 L_nowarmb
    v_mov_b32 v148, 0
    global_load_dword v153, v148, s[18:19]
    v_bfe_u32 v148, v0, 2, 3
    v_lshlrev_b32 v148, 12, v148
    v_and_b32 v149, 3, v0
    v_lshlrev_b32 v149, 7, v149
    s_lshl_b32 s42, s3, 9
    v_add_u32 v149, s42, v149
    v_mov_b32 v150, 2048
    v_cmp_gt_u32 vcc, 32, v0
    s_nop 1
    v_cndmask_b32 v149, v150, v149, vcc
    v_add_u32 v148, v148, v149
    global_load_dword v153, v148, s[46:47] sc1
L_nowarmb:
    s_waitcnt lgkmcnt(0)
    ds_read_b64 v[72:73], v21 offset:0
    ds_read_b64 v[74:75], v21 offset:1024
    s_waitcnt vmcnt(5)
    v_cvt_f32_i32 v7, v100
    v_cvt_f32_i32 v8, v101
    v_cvt_f32_i32 v9, v102
    v_cvt_f32_i32 v10, v103
    s_add_u32 s33, s32, 24576
    buffer_load_dwordx4 v[124:127], v2, s[28:31], s33 offen offset:0 nt
    s_waitcnt vmcnt(5)
    v_cvt_f32_i32 v104, v104
    v_cvt_f32_i32 v105, v105
    v_cvt_f32_i32 v106, v106
    v_cvt_f32_i32 v107, v107
    v_cvt_pk_bf16_f32 v40, v7, v104
    v_cvt_pk_bf16_f32 v42, v8, v105
    v_cvt_pk_bf16_f32 v44, v9, v106
    v_cvt_pk_bf16_f32 v46, v10, v107
    buffer_load_dwordx4 v[128:131], v2, s[28:31], s33 offen offset:1024 nt
    s_waitcnt vmcnt(5)
    v_cvt_f32_i32 v7, v108
    v_cvt_f32_i32 v8, v109
    v_cvt_f32_i32 v9, v110
    v_cvt_f32_i32 v10, v111
    s_add_u32 s33, s32, 32768
    buffer_load_dwordx4 v[84:87], v2, s[28:31], s33 offen offset:0 nt
    s_waitcnt vmcnt(5)
    v_cvt_f32_i32 v112, v112
    v_cvt_f32_i32 v113, v113
    v_cvt_f32_i32 v114, v114
    v_cvt_f32_i32 v115, v115
    v_cvt_pk_bf16_f32 v41, v7, v112
    v_cvt_pk_bf16_f32 v43, v8, v113
    v_cvt_pk_bf16_f32 v45, v9, v114
    v_cvt_pk_bf16_f32 v47, v10, v115
    buffer_load_dwordx4 v[88:91], v2, s[28:31], s33 offen offset:1024 nt
    s_waitcnt lgkmcnt(0)
    v_mfma_f32_4x4x4_16b_bf16 v[56:59], v[72:73], v[40:41], 0
    v_mfma_f32_4x4x4_16b_bf16 v[60:63], v[72:73], v[42:43], 0
    v_mfma_f32_4x4x4_16b_bf16 v[64:67], v[72:73], v[44:45], 0
    v_mfma_f32_4x4x4_16b_bf16 v[68:71], v[72:73], v[46:47], 0
    v_mfma_f32_4x4x4_16b_bf16 v[56:59], v[74:75], v[40:41], v[56:59]
    v_mfma_f32_4x4x4_16b_bf16 v[60:63], v[74:75], v[42:43], v[60:63]
    v_mfma_f32_4x4x4_16b_bf16 v[64:67], v[74:75], v[44:45], v[64:67]
    v_mfma_f32_4x4x4_16b_bf16 v[68:71], v[74:75], v[46:47], v[68:71]
    s_nop 1
    v_add_f32_dpp v25, v25, v25 row_ror:4 row_mask:0xf bank_mask:0xf
    s_nop 1
    v_add_f32_dpp v25, v25, v25 row_ror:8 row_mask:0xf bank_mask:0xf
    v_mov_b32 v3, v25
    s_nop 1
    v_permlane16_swap_b32 v3, v25
    v_add_f32 v25, v25, v3
    v_mov_b32 v3, v25
    s_nop 1
    v_permlane32_swap_b32 v3, v25
    v_add_f32 v25, v25, v3
    s_nop 1
    v_add_f32_dpp v26, v26, v26 row_ror:4 row_mask:0xf bank_mask:0xf
    s_nop 1
    v_add_f32_dpp v26, v26, v26 row_ror:8 row_mask:0xf bank_mask:0xf
    v_mov_b32 v3, v26
    s_nop 1
    v_permlane16_swap_b32 v3, v26
    v_add_f32 v26, v26, v3
    v_mov_b32 v3, v26
    s_nop 1
    v_permlane32_swap_b32 v3, v26
    v_add_f32 v26, v26, v3
    v_lshlrev_b32 v4, 6, v0
    s_lshl_b32 s42, s3, 4
    v_add_u32 v4, s42, v4
    s_mov_b64 exec, 0xf
    ds_write_b128 v4, v[24:27] offset:16384
    s_mov_b64 exec, -1
    ds_read_b64 v[76:77], v21 offset:256
    ds_read_b64 v[78:79], v21 offset:1280
    s_waitcnt vmcnt(5)
    v_cvt_f32_i32 v7, v116
    v_cvt_f32_i32 v8, v117
    v_cvt_f32_i32 v9, v118
    v_cvt_f32_i32 v10, v119
    s_add_u32 s33, s32, 40960
    buffer_load_dwordx4 v[92:95], v2, s[28:31], s33 offen offset:0 nt
    s_waitcnt vmcnt(5)
    v_cvt_f32_i32 v120, v120
    v_cvt_f32_i32 v121, v121
    v_cvt_f32_i32 v122, v122
    v_cvt_f32_i32 v123, v123
    v_cvt_pk_bf16_f32 v40, v7, v120
    v_cvt_pk_bf16_f32 v42, v8, v121
    v_cvt_pk_bf16_f32 v44, v9, v122
    v_cvt_pk_bf16_f32 v46, v10, v123
    buffer_load_dwordx4 v[96:99], v2, s[28:31], s33 offen offset:1024 nt
    s_waitcnt vmcnt(5)
    v_cvt_f32_i32 v7, v124
    v_cvt_f32_i32 v8, v125
    v_cvt_f32_i32 v9, v126
    v_cvt_f32_i32 v10, v127
    s_add_u32 s33, s32, 49152
    buffer_load_dwordx4 v[100:103], v2, s[28:31], s33 offen offset:0 nt
    s_waitcnt vmcnt(5)
    v_cvt_f32_i32 v128, v128
    v_cvt_f32_i32 v129, v129
    v_cvt_f32_i32 v130, v130
    v_cvt_f32_i32 v131, v131
    v_cvt_pk_bf16_f32 v41, v7, v128
    v_cvt_pk_bf16_f32 v43, v8, v129
    v_cvt_pk_bf16_f32 v45, v9, v130
    v_cvt_pk_bf16_f32 v47, v10, v131
    buffer_load_dwordx4 v[104:107], v2, s[28:31], s33 offen offset:1024 nt
    s_waitcnt lgkmcnt(0)
    v_mfma_f32_4x4x4_16b_bf16 v[56:59], v[76:77], v[40:41], v[56:59]
    v_mfma_f32_4x4x4_16b_bf16 v[60:63], v[76:77], v[42:43], v[60:63]
    v_mfma_f32_4x4x4_16b_bf16 v[64:67], v[76:77], v[44:45], v[64:67]
    v_mfma_f32_4x4x4_16b_bf16 v[68:71], v[76:77], v[46:47], v[68:71]
    v_mfma_f32_4x4x4_16b_bf16 v[56:59], v[78:79], v[40:41], v[56:59]
    v_mfma_f32_4x4x4_16b_bf16 v[60:63], v[78:79], v[42:43], v[60:63]
    v_mfma_f32_4x4x4_16b_bf16 v[64:67], v[78:79], v[44:45], v[64:67]
    v_mfma_f32_4x4x4_16b_bf16 v[68:71], v[78:79], v[46:47], v[68:71]
    s_lshl_b32 s42, s3, 11
    v_lshl_add_u32 v148, v0, 3, s42
    s_lshl_b32 s42, s3, 9
    v_lshl_add_u32 v149, v0, 3, s42
    s_lshl_b32 s42, s3, 4
    v_mov_b32 v150, s42
    v_and_b32 v152, 7, v0
    v_lshlrev_b32 v152, 12, v152
    v_add_u32 v152, s42, v152
    v_add_u32 v160, 0, v149
    v_add_u32 v161, 4096, v149
    v_add_u32 v162, 8192, v149
    v_add_u32 v163, 12288, v149
    v_add_u32 v164, 16384, v149
    v_add_u32 v165, 20480, v149
    v_add_u32 v166, 24576, v149
    v_add_u32 v167, 28672, v149
    v_and_b32 v151, 31, v0
    v_lshlrev_b32 v151, 3, v151
    v_lshrrev_b32 v6, 5, v0
    v_lshl_or_b32 v151, v6, 2, v151
    s_lshl_b32 s42, s40, 10
    s_lshl_b32 s43, s3, 8
    s_add_u32 s42, s42, s43
    v_add_u32 v151, s42, v151
    ds_read_b64 v[72:73], v21 offset:64
    ds_read_b64 v[74:75], v21 offset:1088
    s_waitcnt vmcnt(5)
    v_cvt_f32_i32 v7, v84
    v_cvt_f32_i32 v8, v85
    v_cvt_f32_i32 v9, v86
    v_cvt_f32_i32 v10, v87
    s_add_u32 s33, s32, 57344
    buffer_load_dwordx4 v[108:111], v2, s[28:31], s33 offen offset:0 nt
    s_waitcnt vmcnt(5)
    v_cvt_f32_i32 v88, v88
    v_cvt_f32_i32 v89, v89
    v_cvt_f32_i32 v90, v90
    v_cvt_f32_i32 v91, v91
    v_cvt_pk_bf16_f32 v40, v7, v88
    v_cvt_pk_bf16_f32 v42, v8, v89
    v_cvt_pk_bf16_f32 v44, v9, v90
    v_cvt_pk_bf16_f32 v46, v10, v91
    buffer_load_dwordx4 v[112:115], v2, s[28:31], s33 offen offset:1024 nt
    v_add_u32 v22, 1, v80
    s_movk_i32 s55, 0xff
    s_getreg_b32 s42, hwreg(HW_REG_XCC_ID, 0, 4)
    v_xor_b32 v82, v82, v22
    v_xor_b32 v83, s42, v83
    v_or_b32 v82, v82, v83
    s_nop 0
    v_readfirstlane_b32 s54, v82
    s_waitcnt vmcnt(5)
    v_cvt_f32_i32 v7, v92
    v_cvt_f32_i32 v8, v93
    v_cvt_f32_i32 v9, v94
    v_cvt_f32_i32 v10, v95
    s_add_u32 s33, s32, 65536
    buffer_load_dwordx4 v[116:119], v2, s[28:31], s33 offen offset:0 nt
    s_waitcnt vmcnt(5)
    v_cvt_f32_i32 v96, v96
    v_cvt_f32_i32 v97, v97
    v_cvt_f32_i32 v98, v98
    v_cvt_f32_i32 v99, v99
    v_cvt_pk_bf16_f32 v41, v7, v96
    v_cvt_pk_bf16_f32 v43, v8, v97
    v_cvt_pk_bf16_f32 v45, v9, v98
    v_cvt_pk_bf16_f32 v47, v10, v99
    buffer_load_dwordx4 v[120:123], v2, s[28:31], s33 offen offset:1024 nt
    s_waitcnt lgkmcnt(0)
    v_mfma_f32_4x4x4_16b_bf16 v[56:59], v[72:73], v[40:41], v[56:59]
    v_mfma_f32_4x4x4_16b_bf16 v[60:63], v[72:73], v[42:43], v[60:63]
    v_mfma_f32_4x4x4_16b_bf16 v[64:67], v[72:73], v[44:45], v[64:67]
    v_mfma_f32_4x4x4_16b_bf16 v[68:71], v[72:73], v[46:47], v[68:71]
    v_mfma_f32_4x4x4_16b_bf16 v[56:59], v[74:75], v[40:41], v[56:59]
    v_mfma_f32_4x4x4_16b_bf16 v[60:63], v[74:75], v[42:43], v[60:63]
    v_mfma_f32_4x4x4_16b_bf16 v[64:67], v[74:75], v[44:45], v[64:67]
    v_mfma_f32_4x4x4_16b_bf16 v[68:71], v[74:75], v[46:47], v[68:71]
    ds_read_b64 v[76:77], v21 offset:320
    ds_read_b64 v[78:79], v21 offset:1344
    s_barrier
    v_and_b32 v5, 3, v0
    s_lshl_b32 s42, s3, 6
    v_lshl_add_u32 v5, v5, 4, s42
    ds_read_b128 v[168:171], v5 offset:16384
    s_waitcnt vmcnt(5)
    v_cvt_f32_i32 v7, v100
    v_cvt_f32_i32 v8, v101
    v_cvt_f32_i32 v9, v102
    v_cvt_f32_i32 v10, v103
    s_add_u32 s33, s32, 73728
    buffer_load_dwordx4 v[124:127], v2, s[28:31], s33 offen offset:0 nt
    s_waitcnt vmcnt(5)
    v_cvt_f32_i32 v104, v104
    v_cvt_f32_i32 v105, v105
    v_cvt_f32_i32 v106, v106
    v_cvt_f32_i32 v107, v107
    v_cvt_pk_bf16_f32 v40, v7, v104
    v_cvt_pk_bf16_f32 v42, v8, v105
    v_cvt_pk_bf16_f32 v44, v9, v106
    v_cvt_pk_bf16_f32 v46, v10, v107
    buffer_load_dwordx4 v[128:131], v2, s[28:31], s33 offen offset:1024 nt
    s_waitcnt vmcnt(5)
    v_cvt_f32_i32 v7, v108
    v_cvt_f32_i32 v8, v109
    v_cvt_f32_i32 v9, v110
    v_cvt_f32_i32 v10, v111
    s_add_u32 s33, s32, 81920
    buffer_load_dwordx4 v[84:87], v2, s[28:31], s33 offen offset:0 nt
    s_waitcnt vmcnt(5)
    v_cvt_f32_i32 v112, v112
    v_cvt_f32_i32 v113, v113
    v_cvt_f32_i32 v114, v114
    v_cvt_f32_i32 v115, v115
    v_cvt_pk_bf16_f32 v41, v7, v112
    v_cvt_pk_bf16_f32 v43, v8, v113
    v_cvt_pk_bf16_f32 v45, v9, v114
    v_cvt_pk_bf16_f32 v47, v10, v115
    buffer_load_dwordx4 v[88:91], v2, s[28:31], s33 offen offset:1024 nt
    s_waitcnt lgkmcnt(0)
    v_mfma_f32_4x4x4_16b_bf16 v[56:59], v[76:77], v[40:41], v[56:59]
    v_mfma_f32_4x4x4_16b_bf16 v[60:63], v[76:77], v[42:43], v[60:63]
    v_mfma_f32_4x4x4_16b_bf16 v[64:67], v[76:77], v[44:45], v[64:67]
    v_mfma_f32_4x4x4_16b_bf16 v[68:71], v[76:77], v[46:47], v[68:71]
    v_mfma_f32_4x4x4_16b_bf16 v[56:59], v[78:79], v[40:41], v[56:59]
    v_mfma_f32_4x4x4_16b_bf16 v[60:63], v[78:79], v[42:43], v[60:63]
    v_mfma_f32_4x4x4_16b_bf16 v[64:67], v[78:79], v[44:45], v[64:67]
    v_mfma_f32_4x4x4_16b_bf16 v[68:71], v[78:79], v[46:47], v[68:71]
    v_max_f32_dpp v24, v168, v168 row_ror:2 row_mask:0xf bank_mask:0xf
    s_nop 1
    v_max_f32_dpp v24, v24, v24 row_ror:1 row_mask:0xf bank_mask:0xf
    v_and_b32 v24, 0xffffff00, v24
    v_sub_f32 v23, v168, v24
    v_exp_f32 v23, v23
    v_bfi_b32 v156, s55, v22, v24
    v_mul_f32 v25, v23, v169
    v_mul_f32 v26, v23, v170
    v_mov_b32 v158, v22
    v_add_f32_dpp v25, v25, v25 row_ror:2 row_mask:0xf bank_mask:0xf
    s_nop 1
    v_add_f32_dpp v25, v25, v25 row_ror:1 row_mask:0xf bank_mask:0xf
    v_mov_b32 v159, v22
    v_add_f32_dpp v26, v26, v26 row_ror:2 row_mask:0xf bank_mask:0xf
    s_nop 1
    v_add_f32_dpp v26, v26, v26 row_ror:1 row_mask:0xf bank_mask:0xf
    v_bfi_b32 v157, s55, v22, v25
    v_sub_f32 v154, 0, v26
    v_sub_f32 v155, 0, v26
    s_cmp_eq_u32 s54, 0
    s_cbranch_scc1 L_pubfast_s
    s_mov_b64 exec, 1
    global_store_dwordx4 v150, v[156:159], s[44:45] offset:2048 sc1
    s_mov_b64 exec, -1
    s_branch L_pubdone_s
L_pubfast_s:
    s_mov_b64 exec, 1
    global_store_dwordx4 v150, v[156:159], s[44:45] offset:2048
    s_mov_b64 exec, -1
L_pubdone_s:
    ds_read_b64 v[72:73], v21 offset:128
    ds_read_b64 v[74:75], v21 offset:1152
    s_waitcnt vmcnt(5)
    v_cvt_f32_i32 v7, v116
    v_cvt_f32_i32 v8, v117
    v_cvt_f32_i32 v9, v118
    v_cvt_f32_i32 v10, v119
    s_add_u32 s33, s32, 90112
    buffer_load_dwordx4 v[92:95], v2, s[28:31], s33 offen offset:0 nt
    s_waitcnt vmcnt(5)
    v_cvt_f32_i32 v120, v120
    v_cvt_f32_i32 v121, v121
    v_cvt_f32_i32 v122, v122
    v_cvt_f32_i32 v123, v123
    v_cvt_pk_bf16_f32 v40, v7, v120
    v_cvt_pk_bf16_f32 v42, v8, v121
    v_cvt_pk_bf16_f32 v44, v9, v122
    v_cvt_pk_bf16_f32 v46, v10, v123
    buffer_load_dwordx4 v[96:99], v2, s[28:31], s33 offen offset:1024 nt
    s_waitcnt vmcnt(5)
    v_cvt_f32_i32 v7, v124
    v_cvt_f32_i32 v8, v125
    v_cvt_f32_i32 v9, v126
    v_cvt_f32_i32 v10, v127
    s_add_u32 s33, s32, 98304
    buffer_load_dwordx4 v[100:103], v2, s[28:31], s33 offen offset:0 nt
    s_waitcnt vmcnt(5)
    v_cvt_f32_i32 v128, v128
    v_cvt_f32_i32 v129, v129
    v_cvt_f32_i32 v130, v130
    v_cvt_f32_i32 v131, v131
    v_cvt_pk_bf16_f32 v41, v7, v128
    v_cvt_pk_bf16_f32 v43, v8, v129
    v_cvt_pk_bf16_f32 v45, v9, v130
    v_cvt_pk_bf16_f32 v47, v10, v131
    buffer_load_dwordx4 v[104:107], v2, s[28:31], s33 offen offset:1024 nt
    s_waitcnt lgkmcnt(0)
    v_mfma_f32_4x4x4_16b_bf16 v[56:59], v[72:73], v[40:41], v[56:59]
    v_mfma_f32_4x4x4_16b_bf16 v[60:63], v[72:73], v[42:43], v[60:63]
    v_mfma_f32_4x4x4_16b_bf16 v[64:67], v[72:73], v[44:45], v[64:67]
    v_mfma_f32_4x4x4_16b_bf16 v[68:71], v[72:73], v[46:47], v[68:71]
    v_mfma_f32_4x4x4_16b_bf16 v[56:59], v[74:75], v[40:41], v[56:59]
    v_mfma_f32_4x4x4_16b_bf16 v[60:63], v[74:75], v[42:43], v[60:63]
    v_mfma_f32_4x4x4_16b_bf16 v[64:67], v[74:75], v[44:45], v[64:67]
    v_mfma_f32_4x4x4_16b_bf16 v[68:71], v[74:75], v[46:47], v[68:71]
    ds_read_b64 v[76:77], v21 offset:384
    ds_read_b64 v[78:79], v21 offset:1408
    s_waitcnt vmcnt(5)
    v_cvt_f32_i32 v7, v84
    v_cvt_f32_i32 v8, v85
    v_cvt_f32_i32 v9, v86
    v_cvt_f32_i32 v10, v87
    s_add_u32 s33, s32, 106496
    buffer_load_dwordx4 v[108:111], v2, s[28:31], s33 offen offset:0 nt
    s_waitcnt vmcnt(5)
    v_cvt_f32_i32 v88, v88
    v_cvt_f32_i32 v89, v89
    v_cvt_f32_i32 v90, v90
    v_cvt_f32_i32 v91, v91
    v_cvt_pk_bf16_f32 v40, v7, v88
    v_cvt_pk_bf16_f32 v42, v8, v89
    v_cvt_pk_bf16_f32 v44, v9, v90
    v_cvt_pk_bf16_f32 v46, v10, v91
    buffer_load_dwordx4 v[112:115], v2, s[28:31], s33 offen offset:1024 nt
    s_waitcnt vmcnt(5)
    v_cvt_f32_i32 v7, v92
    v_cvt_f32_i32 v8, v93
    v_cvt_f32_i32 v9, v94
    v_cvt_f32_i32 v10, v95
    s_add_u32 s33, s32, 114688
    buffer_load_dwordx4 v[116:119], v2, s[28:31], s33 offen offset:0 nt
    s_waitcnt vmcnt(5)
    v_cvt_f32_i32 v96, v96
    v_cvt_f32_i32 v97, v97
    v_cvt_f32_i32 v98, v98
    v_cvt_f32_i32 v99, v99
    v_cvt_pk_bf16_f32 v41, v7, v96
    v_cvt_pk_bf16_f32 v43, v8, v97
    v_cvt_pk_bf16_f32 v45, v9, v98
    v_cvt_pk_bf16_f32 v47, v10, v99
    buffer_load_dwordx4 v[120:123], v2, s[28:31], s33 offen offset:1024 nt
    s_waitcnt lgkmcnt(0)
    v_mfma_f32_4x4x4_16b_bf16 v[56:59], v[76:77], v[40:41], v[56:59]
    v_mfma_f32_4x4x4_16b_bf16 v[60:63], v[76:77], v[42:43], v[60:63]
    v_mfma_f32_4x4x4_16b_bf16 v[64:67], v[76:77], v[44:45], v[64:67]
    v_mfma_f32_4x4x4_16b_bf16 v[68:71], v[76:77], v[46:47], v[68:71]
    v_mfma_f32_4x4x4_16b_bf16 v[56:59], v[78:79], v[40:41], v[56:59]
    v_mfma_f32_4x4x4_16b_bf16 v[60:63], v[78:79], v[42:43], v[60:63]
    v_mfma_f32_4x4x4_16b_bf16 v[64:67], v[78:79], v[44:45], v[64:67]
    v_mfma_f32_4x4x4_16b_bf16 v[68:71], v[78:79], v[46:47], v[68:71]
    ds_read_b64 v[72:73], v21 offset:192
    ds_read_b64 v[74:75], v21 offset:1216
    s_waitcnt vmcnt(5)
    v_cvt_f32_i32 v7, v100
    v_cvt_f32_i32 v8, v101
    v_cvt_f32_i32 v9, v102
    v_cvt_f32_i32 v10, v103
    s_add_u32 s33, s32, 122880
    buffer_load_dwordx4 v[124:127], v2, s[28:31], s33 offen offset:0 nt
    s_waitcnt vmcnt(5)
    v_cvt_f32_i32 v104, v104
    v_cvt_f32_i32 v105, v105
    v_cvt_f32_i32 v106, v106
    v_cvt_f32_i32 v107, v107
    v_cvt_pk_bf16_f32 v40, v7, v104
    v_cvt_pk_bf16_f32 v42, v8, v105
    v_cvt_pk_bf16_f32 v44, v9, v106
    v_cvt_pk_bf16_f32 v46, v10, v107
    buffer_load_dwordx4 v[128:131], v2, s[28:31], s33 offen offset:1024 nt
    s_waitcnt vmcnt(5)
    v_cvt_f32_i32 v7, v108
    v_cvt_f32_i32 v8, v109
    v_cvt_f32_i32 v9, v110
    v_cvt_f32_i32 v10, v111
    s_add_u32 s33, s32, 131072
    buffer_load_dwordx4 v[84:87], v2, s[28:31], s33 offen offset:0 nt
    s_waitcnt vmcnt(5)
    v_cvt_f32_i32 v112, v112
    v_cvt_f32_i32 v113, v113
    v_cvt_f32_i32 v114, v114
    v_cvt_f32_i32 v115, v115
    v_cvt_pk_bf16_f32 v41, v7, v112
    v_cvt_pk_bf16_f32 v43, v8, v113
    v_cvt_pk_bf16_f32 v45, v9, v114
    v_cvt_pk_bf16_f32 v47, v10, v115
    buffer_load_dwordx4 v[88:91], v2, s[28:31], s33 offen offset:1024 nt
    s_add_u32 s33, s32, 139264
    buffer_load_dwordx4 v[92:95], v2, s[28:31], s33 offen offset:0 nt
    s_waitcnt lgkmcnt(0)
    v_mfma_f32_4x4x4_16b_bf16 v[56:59], v[72:73], v[40:41], v[56:59]
    v_mfma_f32_4x4x4_16b_bf16 v[60:63], v[72:73], v[42:43], v[60:63]
    v_mfma_f32_4x4x4_16b_bf16 v[64:67], v[72:73], v[44:45], v[64:67]
    v_mfma_f32_4x4x4_16b_bf16 v[68:71], v[72:73], v[46:47], v[68:71]
    v_mfma_f32_4x4x4_16b_bf16 v[56:59], v[74:75], v[40:41], v[56:59]
    v_mfma_f32_4x4x4_16b_bf16 v[60:63], v[74:75], v[42:43], v[60:63]
    v_mfma_f32_4x4x4_16b_bf16 v[64:67], v[74:75], v[44:45], v[64:67]
    v_mfma_f32_4x4x4_16b_bf16 v[68:71], v[74:75], v[46:47], v[68:71]
    ds_read_b64 v[76:77], v21 offset:448
    ds_read_b64 v[78:79], v21 offset:1472
    s_waitcnt vmcnt(6)
    v_cvt_f32_i32 v7, v116
    v_cvt_f32_i32 v8, v117
    v_cvt_f32_i32 v9, v118
    v_cvt_f32_i32 v10, v119
    buffer_load_dwordx4 v[96:99], v2, s[28:31], s33 offen offset:1024 nt
    s_waitcnt vmcnt(6)
    v_cvt_f32_i32 v120, v120
    v_cvt_f32_i32 v121, v121
    v_cvt_f32_i32 v122, v122
    v_cvt_f32_i32 v123, v123
    v_cvt_pk_bf16_f32 v40, v7, v120
    v_cvt_pk_bf16_f32 v42, v8, v121
    v_cvt_pk_bf16_f32 v44, v9, v122
    v_cvt_pk_bf16_f32 v46, v10, v123
    s_add_u32 s33, s32, 147456
    buffer_load_dwordx4 v[100:103], v2, s[28:31], s33 offen offset:0 nt
    s_waitcnt vmcnt(6)
    v_cvt_f32_i32 v7, v124
    v_cvt_f32_i32 v8, v125
    v_cvt_f32_i32 v9, v126
    v_cvt_f32_i32 v10, v127
    buffer_load_dwordx4 v[104:107], v2, s[28:31], s33 offen offset:1024 nt
    s_add_u32 s33, s32, 155648
    buffer_load_dwordx4 v[108:111], v2, s[28:31], s33 offen offset:0 nt
    s_waitcnt vmcnt(7)
    v_cvt_f32_i32 v128, v128
    v_cvt_f32_i32 v129, v129
    v_cvt_f32_i32 v130, v130
    v_cvt_f32_i32 v131, v131
    v_cvt_pk_bf16_f32 v41, v7, v128
    v_cvt_pk_bf16_f32 v43, v8, v129
    v_cvt_pk_bf16_f32 v45, v9, v130
    v_cvt_pk_bf16_f32 v47, v10, v131
    buffer_load_dwordx4 v[112:115], v2, s[28:31], s33 offen offset:1024 nt
    s_waitcnt lgkmcnt(0)
    v_mfma_f32_4x4x4_16b_bf16 v[56:59], v[76:77], v[40:41], v[56:59]
    v_mfma_f32_4x4x4_16b_bf16 v[60:63], v[76:77], v[42:43], v[60:63]
    v_mfma_f32_4x4x4_16b_bf16 v[64:67], v[76:77], v[44:45], v[64:67]
    v_mfma_f32_4x4x4_16b_bf16 v[68:71], v[76:77], v[46:47], v[68:71]
    v_mfma_f32_4x4x4_16b_bf16 v[56:59], v[78:79], v[40:41], v[56:59]
    v_mfma_f32_4x4x4_16b_bf16 v[60:63], v[78:79], v[42:43], v[60:63]
    v_mfma_f32_4x4x4_16b_bf16 v[64:67], v[78:79], v[44:45], v[64:67]
    v_mfma_f32_4x4x4_16b_bf16 v[68:71], v[78:79], v[46:47], v[68:71]
    ds_read_b64 v[72:73], v21 offset:512
    ds_read_b64 v[74:75], v21 offset:1536
    s_waitcnt vmcnt(7)
    v_cvt_f32_i32 v7, v84
    v_cvt_f32_i32 v8, v85
    v_cvt_f32_i32 v9, v86
    v_cvt_f32_i32 v10, v87
    s_add_u32 s33, s32, 163840
    buffer_load_dwordx4 v[116:119], v2, s[28:31], s33 offen offset:0 nt
    s_waitcnt vmcnt(7)
    v_cvt_f32_i32 v88, v88
    v_cvt_f32_i32 v89, v89
    v_cvt_f32_i32 v90, v90
    v_cvt_f32_i32 v91, v91
    v_cvt_pk_bf16_f32 v40, v7, v88
    v_cvt_pk_bf16_f32 v42, v8, v89
    v_cvt_pk_bf16_f32 v44, v9, v90
    v_cvt_pk_bf16_f32 v46, v10, v91
    buffer_load_dwordx4 v[120:123], v2, s[28:31], s33 offen offset:1024 nt
    s_add_u32 s33, s32, 172032
    buffer_load_dwordx4 v[124:127], v2, s[28:31], s33 offen offset:0 nt
    s_waitcnt vmcnt(8)
    v_cvt_f32_i32 v7, v92
    v_cvt_f32_i32 v8, v93
    v_cvt_f32_i32 v9, v94
    v_cvt_f32_i32 v10, v95
    buffer_load_dwordx4 v[128:131], v2, s[28:31], s33 offen offset:1024 nt
    s_waitcnt vmcnt(8)
    v_cvt_f32_i32 v96, v96
    v_cvt_f32_i32 v97, v97
    v_cvt_f32_i32 v98, v98
    v_cvt_f32_i32 v99, v99
    v_cvt_pk_bf16_f32 v41, v7, v96
    v_cvt_pk_bf16_f32 v43, v8, v97
    v_cvt_pk_bf16_f32 v45, v9, v98
    v_cvt_pk_bf16_f32 v47, v10, v99
    s_add_u32 s33, s32, 180224
    buffer_load_dwordx4 v[84:87], v2, s[28:31], s33 offen offset:0 nt
    s_waitcnt lgkmcnt(0)
    v_mfma_f32_4x4x4_16b_bf16 v[56:59], v[72:73], v[40:41], v[56:59]
    v_mfma_f32_4x4x4_16b_bf16 v[60:63], v[72:73], v[42:43], v[60:63]
    v_mfma_f32_4x4x4_16b_bf16 v[64:67], v[72:73], v[44:45], v[64:67]
    v_mfma_f32_4x4x4_16b_bf16 v[68:71], v[72:73], v[46:47], v[68:71]
    v_mfma_f32_4x4x4_16b_bf16 v[56:59], v[74:75], v[40:41], v[56:59]
    v_mfma_f32_4x4x4_16b_bf16 v[60:63], v[74:75], v[42:43], v[60:63]
    v_mfma_f32_4x4x4_16b_bf16 v[64:67], v[74:75], v[44:45], v[64:67]
    v_mfma_f32_4x4x4_16b_bf16 v[68:71], v[74:75], v[46:47], v[68:71]
    ds_read_b64 v[76:77], v21 offset:768
    ds_read_b64 v[78:79], v21 offset:1792
    s_waitcnt vmcnt(8)
    v_cvt_f32_i32 v7, v100
    v_cvt_f32_i32 v8, v101
    v_cvt_f32_i32 v9, v102
    v_cvt_f32_i32 v10, v103
    buffer_load_dwordx4 v[88:91], v2, s[28:31], s33 offen offset:1024 nt
    s_add_u32 s33, s32, 188416
    buffer_load_dwordx4 v[92:95], v2, s[28:31], s33 offen offset:0 nt
    s_waitcnt vmcnt(9)
    v_cvt_f32_i32 v104, v104
    v_cvt_f32_i32 v105, v105
    v_cvt_f32_i32 v106, v106
    v_cvt_f32_i32 v107, v107
    v_cvt_pk_bf16_f32 v40, v7, v104
    v_cvt_pk_bf16_f32 v42, v8, v105
    v_cvt_pk_bf16_f32 v44, v9, v106
    v_cvt_pk_bf16_f32 v46, v10, v107
    buffer_load_dwordx4 v[96:99], v2, s[28:31], s33 offen offset:1024 nt
    s_waitcnt vmcnt(9)
    v_cvt_f32_i32 v7, v108
    v_cvt_f32_i32 v8, v109
    v_cvt_f32_i32 v9, v110
    v_cvt_f32_i32 v10, v111
    s_add_u32 s33, s32, 196608
    buffer_load_dwordx4 v[100:103], v2, s[28:31], s33 offen offset:0 nt
    s_waitcnt vmcnt(9)
    v_cvt_f32_i32 v112, v112
    v_cvt_f32_i32 v113, v113
    v_cvt_f32_i32 v114, v114
    v_cvt_f32_i32 v115, v115
    v_cvt_pk_bf16_f32 v41, v7, v112
    v_cvt_pk_bf16_f32 v43, v8, v113
    v_cvt_pk_bf16_f32 v45, v9, v114
    v_cvt_pk_bf16_f32 v47, v10, v115
    buffer_load_dwordx4 v[104:107], v2, s[28:31], s33 offen offset:1024 nt
    s_add_u32 s33, s32, 204800
    buffer_load_dwordx4 v[108:111], v2, s[28:31], s33 offen offset:0 nt
    s_waitcnt lgkmcnt(0)
    v_mfma_f32_4x4x4_16b_bf16 v[56:59], v[76:77], v[40:41], v[56:59]
    v_mfma_f32_4x4x4_16b_bf16 v[60:63], v[76:77], v[42:43], v[60:63]
    v_mfma_f32_4x4x4_16b_bf16 v[64:67], v[76:77], v[44:45], v[64:67]
    v_mfma_f32_4x4x4_16b_bf16 v[68:71], v[76:77], v[46:47], v[68:71]
    v_mfma_f32_4x4x4_16b_bf16 v[56:59], v[78:79], v[40:41], v[56:59]
    v_mfma_f32_4x4x4_16b_bf16 v[60:63], v[78:79], v[42:43], v[60:63]
    v_mfma_f32_4x4x4_16b_bf16 v[64:67], v[78:79], v[44:45], v[64:67]
    v_mfma_f32_4x4x4_16b_bf16 v[68:71], v[78:79], v[46:47], v[68:71]
    ds_read_b64 v[72:73], v21 offset:576
    ds_read_b64 v[74:75], v21 offset:1600
    s_waitcnt vmcnt(10)
    v_cvt_f32_i32 v7, v116
    v_cvt_f32_i32 v8, v117
    v_cvt_f32_i32 v9, v118
    v_cvt_f32_i32 v10, v119
    buffer_load_dwordx4 v[112:115], v2, s[28:31], s33 offen offset:1024 nt
    s_waitcnt vmcnt(10)
    v_cvt_f32_i32 v120, v120
    v_cvt_f32_i32 v121, v121
    v_cvt_f32_i32 v122, v122
    v_cvt_f32_i32 v123, v123
    v_cvt_pk_bf16_f32 v40, v7, v120
    v_cvt_pk_bf16_f32 v42, v8, v121
    v_cvt_pk_bf16_f32 v44, v9, v122
    v_cvt_pk_bf16_f32 v46, v10, v123
    s_add_u32 s33, s32, 212992
    buffer_load_dwordx4 v[116:119], v2, s[28:31], s33 offen offset:0 nt
    s_waitcnt vmcnt(10)
    v_cvt_f32_i32 v7, v124
    v_cvt_f32_i32 v8, v125
    v_cvt_f32_i32 v9, v126
    v_cvt_f32_i32 v10, v127
    buffer_load_dwordx4 v[120:123], v2, s[28:31], s33 offen offset:1024 nt
    s_add_u32 s33, s32, 221184
    buffer_load_dwordx4 v[124:127], v2, s[28:31], s33 offen offset:0 nt
    s_waitcnt vmcnt(11)
    v_cvt_f32_i32 v128, v128
    v_cvt_f32_i32 v129, v129
    v_cvt_f32_i32 v130, v130
    v_cvt_f32_i32 v131, v131
    v_cvt_pk_bf16_f32 v41, v7, v128
    v_cvt_pk_bf16_f32 v43, v8, v129
    v_cvt_pk_bf16_f32 v45, v9, v130
    v_cvt_pk_bf16_f32 v47, v10, v131
    buffer_load_dwordx4 v[128:131], v2, s[28:31], s33 offen offset:1024 nt
    s_waitcnt lgkmcnt(0)
    v_mfma_f32_4x4x4_16b_bf16 v[56:59], v[72:73], v[40:41], v[56:59]
    v_mfma_f32_4x4x4_16b_bf16 v[60:63], v[72:73], v[42:43], v[60:63]
    v_mfma_f32_4x4x4_16b_bf16 v[64:67], v[72:73], v[44:45], v[64:67]
    v_mfma_f32_4x4x4_16b_bf16 v[68:71], v[72:73], v[46:47], v[68:71]
    v_mfma_f32_4x4x4_16b_bf16 v[56:59], v[74:75], v[40:41], v[56:59]
    v_mfma_f32_4x4x4_16b_bf16 v[60:63], v[74:75], v[42:43], v[60:63]
    v_mfma_f32_4x4x4_16b_bf16 v[64:67], v[74:75], v[44:45], v[64:67]
    v_mfma_f32_4x4x4_16b_bf16 v[68:71], v[74:75], v[46:47], v[68:71]
    ds_read_b64 v[76:77], v21 offset:832
    ds_read_b64 v[78:79], v21 offset:1856
    s_waitcnt vmcnt(11)
    v_cvt_f32_i32 v7, v84
    v_cvt_f32_i32 v8, v85
    v_cvt_f32_i32 v9, v86
    v_cvt_f32_i32 v10, v87
    s_add_u32 s33, s32, 229376
    buffer_load_dwordx4 v[84:87], v2, s[28:31], s33 offen offset:0 nt
    s_waitcnt vmcnt(11)
    v_cvt_f32_i32 v88, v88
    v_cvt_f32_i32 v89, v89
    v_cvt_f32_i32 v90, v90
    v_cvt_f32_i32 v91, v91
    v_cvt_pk_bf16_f32 v40, v7, v88
    v_cvt_pk_bf16_f32 v42, v8, v89
    v_cvt_pk_bf16_f32 v44, v9, v90
    v_cvt_pk_bf16_f32 v46, v10, v91
    buffer_load_dwordx4 v[88:91], v2, s[28:31], s33 offen offset:1024 nt
    s_waitcnt vmcnt(11)
    v_cvt_f32_i32 v7, v92
    v_cvt_f32_i32 v8, v93
    v_cvt_f32_i32 v9, v94
    v_cvt_f32_i32 v10, v95
    s_add_u32 s33, s32, 237568
    buffer_load_dwordx4 v[92:95], v2, s[28:31], s33 offen offset:0 nt
    s_waitcnt vmcnt(11)
    v_cvt_f32_i32 v96, v96
    v_cvt_f32_i32 v97, v97
    v_cvt_f32_i32 v98, v98
    v_cvt_f32_i32 v99, v99
    v_cvt_pk_bf16_f32 v41, v7, v96
    v_cvt_pk_bf16_f32 v43, v8, v97
    v_cvt_pk_bf16_f32 v45, v9, v98
    v_cvt_pk_bf16_f32 v47, v10, v99
    buffer_load_dwordx4 v[96:99], v2, s[28:31], s33 offen offset:1024 nt
    s_waitcnt lgkmcnt(0)
    v_mfma_f32_4x4x4_16b_bf16 v[56:59], v[76:77], v[40:41], v[56:59]
    v_mfma_f32_4x4x4_16b_bf16 v[60:63], v[76:77], v[42:43], v[60:63]
    v_mfma_f32_4x4x4_16b_bf16 v[64:67], v[76:77], v[44:45], v[64:67]
    v_mfma_f32_4x4x4_16b_bf16 v[68:71], v[76:77], v[46:47], v[68:71]
    v_mfma_f32_4x4x4_16b_bf16 v[56:59], v[78:79], v[40:41], v[56:59]
    v_mfma_f32_4x4x4_16b_bf16 v[60:63], v[78:79], v[42:43], v[60:63]
    v_mfma_f32_4x4x4_16b_bf16 v[64:67], v[78:79], v[44:45], v[64:67]
    v_mfma_f32_4x4x4_16b_bf16 v[68:71], v[78:79], v[46:47], v[68:71]
    ds_read_b64 v[72:73], v21 offset:640
    ds_read_b64 v[74:75], v21 offset:1664
    s_waitcnt vmcnt(11)
    v_cvt_f32_i32 v7, v100
    v_cvt_f32_i32 v8, v101
    v_cvt_f32_i32 v9, v102
    v_cvt_f32_i32 v10, v103
    s_add_u32 s33, s32, 245760
    buffer_load_dwordx4 v[100:103], v2, s[28:31], s33 offen offset:0 nt
    s_waitcnt vmcnt(11)
    v_cvt_f32_i32 v104, v104
    v_cvt_f32_i32 v105, v105
    v_cvt_f32_i32 v106, v106
    v_cvt_f32_i32 v107, v107
    v_cvt_pk_bf16_f32 v40, v7, v104
    v_cvt_pk_bf16_f32 v42, v8, v105
    v_cvt_pk_bf16_f32 v44, v9, v106
    v_cvt_pk_bf16_f32 v46, v10, v107
    buffer_load_dwordx4 v[104:107], v2, s[28:31], s33 offen offset:1024 nt
    s_waitcnt vmcnt(11)
    v_cvt_f32_i32 v7, v108
    v_cvt_f32_i32 v8, v109
    v_cvt_f32_i32 v9, v110
    v_cvt_f32_i32 v10, v111
    s_add_u32 s33, s32, 253952
    buffer_load_dwordx4 v[108:111], v2, s[28:31], s33 offen offset:0 nt
    s_waitcnt vmcnt(11)
    v_cvt_f32_i32 v112, v112
    v_cvt_f32_i32 v113, v113
    v_cvt_f32_i32 v114, v114
    v_cvt_f32_i32 v115, v115
    v_cvt_pk_bf16_f32 v41, v7, v112
    v_cvt_pk_bf16_f32 v43, v8, v113
    v_cvt_pk_bf16_f32 v45, v9, v114
    v_cvt_pk_bf16_f32 v47, v10, v115
    buffer_load_dwordx4 v[112:115], v2, s[28:31], s33 offen offset:1024 nt
    s_waitcnt lgkmcnt(0)
    v_mfma_f32_4x4x4_16b_bf16 v[56:59], v[72:73], v[40:41], v[56:59]
    v_mfma_f32_4x4x4_16b_bf16 v[60:63], v[72:73], v[42:43], v[60:63]
    v_mfma_f32_4x4x4_16b_bf16 v[64:67], v[72:73], v[44:45], v[64:67]
    v_mfma_f32_4x4x4_16b_bf16 v[68:71], v[72:73], v[46:47], v[68:71]
    v_mfma_f32_4x4x4_16b_bf16 v[56:59], v[74:75], v[40:41], v[56:59]
    v_mfma_f32_4x4x4_16b_bf16 v[60:63], v[74:75], v[42:43], v[60:63]
    v_mfma_f32_4x4x4_16b_bf16 v[64:67], v[74:75], v[44:45], v[64:67]
    v_mfma_f32_4x4x4_16b_bf16 v[68:71], v[74:75], v[46:47], v[68:71]
    ds_read_b64 v[76:77], v21 offset:896
    ds_read_b64 v[78:79], v21 offset:1920
    s_waitcnt vmcnt(11)
    v_cvt_f32_i32 v7, v116
    v_cvt_f32_i32 v8, v117
    v_cvt_f32_i32 v9, v118
    v_cvt_f32_i32 v10, v119
    s_waitcnt vmcnt(10)
    v_cvt_f32_i32 v120, v120
    v_cvt_f32_i32 v121, v121
    v_cvt_f32_i32 v122, v122
    v_cvt_f32_i32 v123, v123
    v_cvt_pk_bf16_f32 v40, v7, v120
    v_cvt_pk_bf16_f32 v42, v8, v121
    v_cvt_pk_bf16_f32 v44, v9, v122
    v_cvt_pk_bf16_f32 v46, v10, v123
    s_waitcnt vmcnt(9)
    v_cvt_f32_i32 v7, v124
    v_cvt_f32_i32 v8, v125
    v_cvt_f32_i32 v9, v126
    v_cvt_f32_i32 v10, v127
    s_waitcnt vmcnt(8)
    v_cvt_f32_i32 v128, v128
    v_cvt_f32_i32 v129, v129
    v_cvt_f32_i32 v130, v130
    v_cvt_f32_i32 v131, v131
    v_cvt_pk_bf16_f32 v41, v7, v128
    v_cvt_pk_bf16_f32 v43, v8, v129
    v_cvt_pk_bf16_f32 v45, v9, v130
    v_cvt_pk_bf16_f32 v47, v10, v131
    s_waitcnt lgkmcnt(0)
    v_mfma_f32_4x4x4_16b_bf16 v[56:59], v[76:77], v[40:41], v[56:59]
    v_mfma_f32_4x4x4_16b_bf16 v[60:63], v[76:77], v[42:43], v[60:63]
    v_mfma_f32_4x4x4_16b_bf16 v[64:67], v[76:77], v[44:45], v[64:67]
    v_mfma_f32_4x4x4_16b_bf16 v[68:71], v[76:77], v[46:47], v[68:71]
    v_mfma_f32_4x4x4_16b_bf16 v[56:59], v[78:79], v[40:41], v[56:59]
    v_mfma_f32_4x4x4_16b_bf16 v[60:63], v[78:79], v[42:43], v[60:63]
    v_mfma_f32_4x4x4_16b_bf16 v[64:67], v[78:79], v[44:45], v[64:67]
    v_mfma_f32_4x4x4_16b_bf16 v[68:71], v[78:79], v[46:47], v[68:71]
    ds_read_b64 v[72:73], v21 offset:704
    ds_read_b64 v[74:75], v21 offset:1728
    s_waitcnt vmcnt(7)
    v_cvt_f32_i32 v7, v84
    v_cvt_f32_i32 v8, v85
    v_cvt_f32_i32 v9, v86
    v_cvt_f32_i32 v10, v87
    s_waitcnt vmcnt(6)
    v_cvt_f32_i32 v88, v88
    v_cvt_f32_i32 v89, v89
    v_cvt_f32_i32 v90, v90
    v_cvt_f32_i32 v91, v91
    v_cvt_pk_bf16_f32 v40, v7, v88
    v_cvt_pk_bf16_f32 v42, v8, v89
    v_cvt_pk_bf16_f32 v44, v9, v90
    v_cvt_pk_bf16_f32 v46, v10, v91
    s_waitcnt vmcnt(5)
    v_cvt_f32_i32 v7, v92
    v_cvt_f32_i32 v8, v93
    v_cvt_f32_i32 v9, v94
    v_cvt_f32_i32 v10, v95
    s_waitcnt vmcnt(4)
    v_cvt_f32_i32 v96, v96
    v_cvt_f32_i32 v97, v97
    v_cvt_f32_i32 v98, v98
    v_cvt_f32_i32 v99, v99
    v_cvt_pk_bf16_f32 v41, v7, v96
    v_cvt_pk_bf16_f32 v43, v8, v97
    v_cvt_pk_bf16_f32 v45, v9, v98
    v_cvt_pk_bf16_f32 v47, v10, v99
    s_waitcnt lgkmcnt(0)
    v_mfma_f32_4x4x4_16b_bf16 v[56:59], v[72:73], v[40:41], v[56:59]
    v_mfma_f32_4x4x4_16b_bf16 v[60:63], v[72:73], v[42:43], v[60:63]
    v_mfma_f32_4x4x4_16b_bf16 v[64:67], v[72:73], v[44:45], v[64:67]
    v_mfma_f32_4x4x4_16b_bf16 v[68:71], v[72:73], v[46:47], v[68:71]
    v_mfma_f32_4x4x4_16b_bf16 v[56:59], v[74:75], v[40:41], v[56:59]
    v_mfma_f32_4x4x4_16b_bf16 v[60:63], v[74:75], v[42:43], v[60:63]
    v_mfma_f32_4x4x4_16b_bf16 v[64:67], v[74:75], v[44:45], v[64:67]
    v_mfma_f32_4x4x4_16b_bf16 v[68:71], v[74:75], v[46:47], v[68:71]
    ds_read_b64 v[76:77], v21 offset:960
    ds_read_b64 v[78:79], v21 offset:1984
    s_cmp_lg_u32 s41, 7
    s_cbranch_scc1 L_nostpf
    global_load_dwordx4 v[168:171], v152, s[46:47] offset:2048 sc1
L_nostpf:
    s_waitcnt vmcnt(3)
    v_cvt_f32_i32 v7, v100
    v_cvt_f32_i32 v8, v101
    v_cvt_f32_i32 v9, v102
    v_cvt_f32_i32 v10, v103
    s_waitcnt vmcnt(2)
    v_cvt_f32_i32 v104, v104
    v_cvt_f32_i32 v105, v105
    v_cvt_f32_i32 v106, v106
    v_cvt_f32_i32 v107, v107
    v_cvt_pk_bf16_f32 v40, v7, v104
    v_cvt_pk_bf16_f32 v42, v8, v105
    v_cvt_pk_bf16_f32 v44, v9, v106
    v_cvt_pk_bf16_f32 v46, v10, v107
    s_waitcnt vmcnt(1)
    v_cvt_f32_i32 v7, v108
    v_cvt_f32_i32 v8, v109
    v_cvt_f32_i32 v9, v110
    v_cvt_f32_i32 v10, v111
    s_waitcnt vmcnt(0)
    v_cvt_f32_i32 v112, v112
    v_cvt_f32_i32 v113, v113
    v_cvt_f32_i32 v114, v114
    v_cvt_f32_i32 v115, v115
    v_cvt_pk_bf16_f32 v41, v7, v112
    v_cvt_pk_bf16_f32 v43, v8, v113
    v_cvt_pk_bf16_f32 v45, v9, v114
    v_cvt_pk_bf16_f32 v47, v10, v115
    s_waitcnt lgkmcnt(0)
    v_mfma_f32_4x4x4_16b_bf16 v[56:59], v[76:77], v[40:41], v[56:59]
    v_mfma_f32_4x4x4_16b_bf16 v[60:63], v[76:77], v[42:43], v[60:63]
    v_mfma_f32_4x4x4_16b_bf16 v[64:67], v[76:77], v[44:45], v[64:67]
    v_mfma_f32_4x4x4_16b_bf16 v[68:71], v[76:77], v[46:47], v[68:71]
    v_mfma_f32_4x4x4_16b_bf16 v[56:59], v[78:79], v[40:41], v[56:59]
    v_mfma_f32_4x4x4_16b_bf16 v[60:63], v[78:79], v[42:43], v[60:63]
    v_mfma_f32_4x4x4_16b_bf16 v[64:67], v[78:79], v[44:45], v[64:67]
    v_mfma_f32_4x4x4_16b_bf16 v[68:71], v[78:79], v[46:47], v[68:71]
    s_nop 4
    v_permlane32_swap_b32 v56, v64
    v_permlane32_swap_b32 v60, v68
    v_permlane32_swap_b32 v57, v65
    v_permlane32_swap_b32 v61, v69
    v_permlane32_swap_b32 v58, v66
    v_permlane32_swap_b32 v62, v70
    v_permlane32_swap_b32 v59, v67
    v_permlane32_swap_b32 v63, v71
    v_add_f32 v40, v56, v64
    v_add_f32 v41, v60, v68
    ds_write_b64 v148, v[40:41] offset:8192
    v_add_f32 v42, v57, v65
    v_add_f32 v43, v61, v69
    ds_write_b64 v148, v[42:43] offset:8704
    v_add_f32 v44, v58, v66
    v_add_f32 v45, v62, v70
    ds_write_b64 v148, v[44:45] offset:9216
    v_add_f32 v46, v59, v67
    v_add_f32 v47, v63, v71
    ds_write_b64 v148, v[46:47] offset:9728
    s_waitcnt lgkmcnt(0)
    s_barrier
    ds_read_b64 v[84:85], v149 offset:8192
    ds_read_b64 v[86:87], v149 offset:10240
    ds_read_b64 v[88:89], v149 offset:12288
    ds_read_b64 v[90:91], v149 offset:14336
    s_waitcnt lgkmcnt(3)
    v_fmac_f32_dpp v154, v23, v84 row_newbcast:0 row_mask:0xf bank_mask:0xf
    v_fmac_f32_dpp v155, v23, v85 row_newbcast:0 row_mask:0xf bank_mask:0xf
    s_waitcnt lgkmcnt(2)
    v_fmac_f32_dpp v154, v23, v86 row_newbcast:1 row_mask:0xf bank_mask:0xf
    v_fmac_f32_dpp v155, v23, v87 row_newbcast:1 row_mask:0xf bank_mask:0xf
    s_waitcnt lgkmcnt(1)
    v_fmac_f32_dpp v154, v23, v88 row_newbcast:2 row_mask:0xf bank_mask:0xf
    v_fmac_f32_dpp v155, v23, v89 row_newbcast:2 row_mask:0xf bank_mask:0xf
    s_waitcnt lgkmcnt(0)
    v_fmac_f32_dpp v154, v23, v90 row_newbcast:3 row_mask:0xf bank_mask:0xf
    v_fmac_f32_dpp v155, v23, v91 row_newbcast:3 row_mask:0xf bank_mask:0xf
    v_bfi_b32 v154, s55, v22, v154
    v_bfi_b32 v155, s55, v22, v155
    s_cmp_eq_u32 s54, 0
    s_cbranch_scc1 L_pubfast_d
    global_store_dwordx2 v149, v[154:155], s[44:45] sc1
    s_branch L_pubdone_d
L_pubfast_d:
    global_store_dwordx2 v149, v[154:155], s[44:45]
L_pubdone_d:
    s_cmp_lg_u32 s41, 7
    s_cbranch_scc1 L_end
    global_load_dwordx2 v[172:173], v160, s[46:47] sc1
    global_load_dwordx2 v[174:175], v161, s[46:47] sc1
    global_load_dwordx2 v[176:177], v162, s[46:47] sc1
    global_load_dwordx2 v[178:179], v163, s[46:47] sc1
    global_load_dwordx2 v[180:181], v164, s[46:47] sc1
    global_load_dwordx2 v[182:183], v165, s[46:47] sc1
    global_load_dwordx2 v[184:185], v166, s[46:47] sc1
    global_load_dwordx2 v[186:187], v167, s[46:47] sc1
    s_mov_b32 s52, 262144
L_stchk:
    v_xor_b32 v3, v168, v22
    v_bitop3_b32 v3, v169, v3, v22 bitop3:0xde
    v_xor_b32 v6, v170, v22
    v_bitop3_b32 v6, v171, v6, v22 bitop3:0xde
    v_and_or_b32 v3, v3, s55, v6
    v_cmp_ne_u32 vcc, 0, v3
    s_cbranch_vccz L_stok
    s_sub_u32 s52, s52, 1
    s_cbranch_scc1 L_end
    global_load_dwordx4 v[168:171], v152, s[46:47] offset:2048 sc1
    s_waitcnt vmcnt(0)
    s_branch L_stchk
L_stok:
    s_mov_b32 s43, 0xffffff00
    v_and_b32 v168, s43, v168
    v_and_b32 v169, s43, v169
    s_nop 0
    v_max_f32_dpp v24, v168, v168 row_ror:4 row_mask:0xf bank_mask:0xf
    s_nop 1
    v_max_f32_dpp v24, v24, v24 row_ror:2 row_mask:0xf bank_mask:0xf
    s_nop 1
    v_max_f32_dpp v24, v24, v24 row_ror:1 row_mask:0xf bank_mask:0xf
    v_sub_f32 v23, v168, v24
    v_exp_f32 v23, v23
    s_nop 0
    v_mul_f32 v25, v23, v169
    s_nop 1
    v_add_f32_dpp v25, v25, v25 row_ror:4 row_mask:0xf bank_mask:0xf
    s_nop 1
    v_add_f32_dpp v25, v25, v25 row_ror:2 row_mask:0xf bank_mask:0xf
    s_nop 1
    v_add_f32_dpp v25, v25, v25 row_ror:1 row_mask:0xf bank_mask:0xf
    v_rcp_f32 v3, v25
    s_nop 0
    v_mul_f32 v23, v23, v3
L_dchk:
    s_waitcnt vmcnt(7)
    v_xor_b32 v3, v172, v22
    v_bitop3_b32 v3, v173, v3, v22 bitop3:0xde
    v_and_b32 v172, s43, v172
    v_and_b32 v173, s43, v173
    s_waitcnt vmcnt(6)
    v_bitop3_b32 v3, v174, v3, v22 bitop3:0xde
    v_bitop3_b32 v3, v175, v3, v22 bitop3:0xde
    v_and_b32 v174, s43, v174
    v_and_b32 v175, s43, v175
    s_waitcnt vmcnt(5)
    v_bitop3_b32 v3, v176, v3, v22 bitop3:0xde
    v_bitop3_b32 v3, v177, v3, v22 bitop3:0xde
    v_and_b32 v176, s43, v176
    v_and_b32 v177, s43, v177
    s_waitcnt vmcnt(4)
    v_bitop3_b32 v3, v178, v3, v22 bitop3:0xde
    v_bitop3_b32 v3, v179, v3, v22 bitop3:0xde
    v_and_b32 v178, s43, v178
    v_and_b32 v179, s43, v179
    s_waitcnt vmcnt(3)
    v_bitop3_b32 v3, v180, v3, v22 bitop3:0xde
    v_bitop3_b32 v3, v181, v3, v22 bitop3:0xde
    v_and_b32 v180, s43, v180
    v_and_b32 v181, s43, v181
    s_waitcnt vmcnt(2)
    v_bitop3_b32 v3, v182, v3, v22 bitop3:0xde
    v_bitop3_b32 v3, v183, v3, v22 bitop3:0xde
    v_and_b32 v182, s43, v182
    v_and_b32 v183, s43, v183
    s_waitcnt vmcnt(1)
    v_bitop3_b32 v3, v184, v3, v22 bitop3:0xde
    v_bitop3_b32 v3, v185, v3, v22 bitop3:0xde
    v_and_b32 v184, s43, v184
    v_and_b32 v185, s43, v185
    s_waitcnt vmcnt(0)
    v_bitop3_b32 v3, v186, v3, v22 bitop3:0xde
    v_bitop3_b32 v3, v187, v3, v22 bitop3:0xde
    v_and_b32 v186, s43, v186
    v_and_b32 v187, s43, v187
    v_and_b32 v3, s55, v3
    v_cmp_ne_u32 vcc, 0, v3
    s_cbranch_vccz L_ready
    s_sub_u32 s52, s52, 1
    s_cbranch_scc1 L_end
    global_load_dwordx2 v[172:173], v160, s[46:47] sc1
    global_load_dwordx2 v[174:175], v161, s[46:47] sc1
    global_load_dwordx2 v[176:177], v162, s[46:47] sc1
    global_load_dwordx2 v[178:179], v163, s[46:47] sc1
    global_load_dwordx2 v[180:181], v164, s[46:47] sc1
    global_load_dwordx2 v[182:183], v165, s[46:47] sc1
    global_load_dwordx2 v[184:185], v166, s[46:47] sc1
    global_load_dwordx2 v[186:187], v167, s[46:47] sc1
    s_branch L_dchk
L_ready:
    v_mul_f32_dpp v154, v23, v172 row_newbcast:0 row_mask:0xf bank_mask:0xf
    v_mul_f32_dpp v155, v23, v173 row_newbcast:0 row_mask:0xf bank_mask:0xf
    v_fmac_f32_dpp v154, v23, v174 row_newbcast:1 row_mask:0xf bank_mask:0xf
    v_fmac_f32_dpp v155, v23, v175 row_newbcast:1 row_mask:0xf bank_mask:0xf
    v_fmac_f32_dpp v154, v23, v176 row_newbcast:2 row_mask:0xf bank_mask:0xf
    v_fmac_f32_dpp v155, v23, v177 row_newbcast:2 row_mask:0xf bank_mask:0xf
    v_fmac_f32_dpp v154, v23, v178 row_newbcast:3 row_mask:0xf bank_mask:0xf
    v_fmac_f32_dpp v155, v23, v179 row_newbcast:3 row_mask:0xf bank_mask:0xf
    v_fmac_f32_dpp v154, v23, v180 row_newbcast:4 row_mask:0xf bank_mask:0xf
    v_fmac_f32_dpp v155, v23, v181 row_newbcast:4 row_mask:0xf bank_mask:0xf
    v_fmac_f32_dpp v154, v23, v182 row_newbcast:5 row_mask:0xf bank_mask:0xf
    v_fmac_f32_dpp v155, v23, v183 row_newbcast:5 row_mask:0xf bank_mask:0xf
    v_fmac_f32_dpp v154, v23, v184 row_newbcast:6 row_mask:0xf bank_mask:0xf
    v_fmac_f32_dpp v155, v23, v185 row_newbcast:6 row_mask:0xf bank_mask:0xf
    v_fmac_f32_dpp v154, v23, v186 row_newbcast:7 row_mask:0xf bank_mask:0xf
    v_fmac_f32_dpp v155, v23, v187 row_newbcast:7 row_mask:0xf bank_mask:0xf
    v_cvt_pk_bf16_f32 v3, v154, v155
    global_store_dword v151, v3, s[18:19] sc1
    s_cmp_lg_u32 s3, 0
    s_cbranch_scc1 L_nocell
    v_mov_b32 v6, 0
    s_mov_b64 exec, 1
    global_store_dword v6, v22, s[48:49] sc1
    s_mov_b64 exec, -1
L_nocell:
L_end:
    s_endpgm
.section .rodata,"a"
.p2align 6
.amdhsa_kernel standalone__kv_cache_quant_int4_int2_kv_with_per_channel_or_per_token_scales__decode_kernel
  .amdhsa_next_free_vgpr 188
  .amdhsa_next_free_sgpr 64
  .amdhsa_accum_offset 188
  .amdhsa_group_segment_fixed_size 0
  .amdhsa_kernarg_size 80
  .amdhsa_user_sgpr_count 2
  .amdhsa_user_sgpr_kernarg_segment_ptr 1
  .amdhsa_system_sgpr_workgroup_id_x 1
  .amdhsa_float_denorm_mode_32 3
.end_amdhsa_kernel
```
